```python
import torch

def _softmax(x, axis=-1):
    return torch.softmax(x, dim=axis)
def _gelu(x):
    return torch.nn.functional.gelu(x, approximate="tanh")
def _silu(x):
    return torch.nn.functional.silu(x)
def _sigmoid(x):
    return torch.sigmoid(x)
def _layernorm(x, axis=-1, eps=1e-5):
    m = x.mean(dim=axis, keepdim=True)
    v = x.var(dim=axis, keepdim=True, unbiased=False)
    return (x - m) / torch.sqrt(v + eps)
def _scatter_add(tgt, idx, src, axis=0):
    return tgt.clone().index_add_(axis, idx, src)
def _segment_sum(src, seg, n):
    out = torch.zeros((n,) + src.shape[1:], dtype=src.dtype)
    return out.index_add_(0, seg, src)
def _pad(x, pw):
    flat = tuple(v for pair in reversed(pw) for v in pair)
    return torch.nn.functional.pad(x, flat)

kernel_name = 'concat_heads__gqa_block_cached__mha_block_cached__near_ridge'

def setup_inputs():

    _w = (lambda a: (lambda t: t.to(torch.bfloat16) if t.is_floating_point() else t)(torch.as_tensor(a)))
    def _A_setup():
        B, Sq, D = 16, 144, 640
        Hq, Hkv, Sk, Dh = 32, 32, 512, 192
        assert Hq % Hkv == 0, (Hq, Hkv)
        return {
            "x": _w((lambda *s: torch.randn(*s, dtype=torch.bfloat16) * 0.8)(B, Sq, D)),
            "k_cache": _w((lambda *s: torch.randn(*s, dtype=torch.bfloat16) * 0.8)(B, Hkv, Sk, Dh)),
            "v_cache": _w((lambda *s: torch.randn(*s, dtype=torch.bfloat16) * 0.05)(B, Hkv, Sk, Dh)),
            "wq": _w((lambda *s: torch.randn(*s, dtype=torch.bfloat16) * 0.8)(D, Hq * Dh) * (D ** -0.5)),
            "wo": _w((lambda *s: torch.randn(*s, dtype=torch.bfloat16) * 0.05)(Hq * Dh, D) * ((Hq * Dh) ** -0.5)),
        }
    _A_in = _A_setup()

    def _B_setup():
        B, Sq, D = 16, 144, 640
        H, Sk, Dh = 32, 512, 192
        return {
            "x": _w((lambda *s: torch.randn(*s, dtype=torch.bfloat16) * 0.8)(B, Sq, D)),
            "k_cache": _w((lambda *s: torch.randn(*s, dtype=torch.bfloat16) * 0.8)(B, H, Sk, Dh)),
            "v_cache": _w((lambda *s: torch.randn(*s, dtype=torch.bfloat16) * 0.05)(B, H, Sk, Dh)),
            "wq": _w((lambda *s: torch.randn(*s, dtype=torch.bfloat16) * 0.8)(D, H * Dh) * (D ** -0.5)),
            "wo": _w((lambda *s: torch.randn(*s, dtype=torch.bfloat16) * 0.05)(H * Dh, D) * ((H * Dh) ** -0.5)),
        }
    _B_in = _B_setup()

    return {
        "A_x": _A_in["x"],
        "A_k_cache": _A_in["k_cache"],
        "A_v_cache": _A_in["v_cache"],
        "A_wq": _A_in["wq"],
        "A_wo": _A_in["wo"],
        "B_x": _B_in["x"],
        "B_k_cache": _B_in["k_cache"],
        "B_v_cache": _B_in["v_cache"],
        "B_wq": _B_in["wq"],
        "B_wo": _B_in["wo"],
    }

def reference(A_x, A_k_cache, A_v_cache, A_wq, A_wo, B_x, B_k_cache, B_v_cache, B_wq, B_wo):
    def _A_ref(x, k_cache, v_cache, wq, wo):
        B, Sq, D = x.shape
        Hq, Dh = 32, 192
        Hkv = k_cache.shape[1]
        rep = Hq // Hkv
        q = (lambda x, *d: x.permute(*d))((x @ wq).reshape(B, Sq, Hq, Dh), 0, 2, 1, 3)
        k = (lambda x, n, axis: torch.repeat_interleave(x, n, dim=axis))(k_cache, rep, axis=1)
        v = (lambda x, n, axis: torch.repeat_interleave(x, n, dim=axis))(v_cache, rep, axis=1)
        scores = torch.einsum("bhqd,bhkd->bhqk", q, k) * (Dh ** -0.5)
        p = _softmax(scores, axis=-1)
        o = torch.einsum("bhqk,bhkd->bhqd", p, v)
        return (lambda x, *d: x.permute(*d))(o, 0, 2, 1, 3).reshape(B, Sq, Hq * Dh) @ wo

    def _B_ref(x, k_cache, v_cache, wq, wo):
        B, Sq, D = x.shape
        H, Dh = 32, 192
        q = (lambda x, *d: x.permute(*d))((x @ wq).reshape(B, Sq, H, Dh), 0, 2, 1, 3)
        scores = torch.einsum("bhqd,bhkd->bhqk", q, k_cache) * (Dh ** -0.5)
        p = _softmax(scores, axis=-1)
        o = torch.einsum("bhqk,bhkd->bhqd", p, v_cache)
        return (lambda x, *d: x.permute(*d))(o, 0, 2, 1, 3).reshape(B, Sq, H * Dh) @ wo

    a = _A_ref(A_x, A_k_cache, A_v_cache, A_wq, A_wo)
    b = _B_ref(B_x, B_k_cache, B_v_cache, B_wq, B_wo)
    return torch.concatenate([a, b], axis=-1)
```

```asm
; @launch kernel=attn_kernel grid=(1024,1,1) block=(256,1,1) lds=79872
; @launch kernel=oproj_kernel grid=(240,1,1) block=(256,1,1) lds=143360
.amdgcn_target "amdgcn-amd-amdhsa--gfx950"
.text
.globl attn_kernel
.p2align 8
.type attn_kernel,@function
attn_kernel:
    s_cmp_ge_u32 s2, 1024
    s_cbranch_scc1 attn_kernel_exit
    s_and_b32 s40, s2, 7
    s_lshr_b32 s41, s2, 3
    s_and_b32 s42, s41, 3
    s_lshr_b32 s60, s41, 2
    s_lshl_b32 s58, s40, 2
    s_add_u32 s58, s58, s42
    s_and_b32 s59, s60, 15
    s_lshr_b32 s43, s60, 4
    s_mul_i32 s43, s43, 40
    s_add_u32 s40, s0, s43
    s_addc_u32 s41, s1, 0
    s_load_dwordx8 s[44:51], s[40:41], 0
    s_load_dwordx2 s[52:53], s[0:1], 96
    v_lshrrev_b32 v6, 6, v0
    s_nop 0
    v_readfirstlane_b32 s24, v6
    v_and_b32 v7, 63, v0
    s_lshl_b32 s25, s24, 10
    s_lshl_b32 s57, s24, 5
    s_add_u32 s57, s57, 16
    s_cmp_eq_u32 s24, 0
    s_cselect_b32 s57, 0, s57
    v_and_b32 v8, 15, v7
    v_lshrrev_b32 v9, 4, v7
    v_bfe_u32 v10, v7, 2, 2
    v_and_b32 v11, 3, v7
    v_lshrrev_b32 v12, 1, v8
    v_xor_b32 v12, v9, v12
    v_lshlrev_b32 v12, 4, v12
    v_lshl_add_u32 v0, v8, 7, v12
    v_lshrrev_b32 v12, 1, v10
    v_and_b32 v13, 1, v9
    v_lshl_or_b32 v12, v13, 1, v12
    v_lshlrev_b32 v12, 1, v12
    v_lshrrev_b32 v13, 1, v11
    v_xor_b32 v12, v12, v13
    v_lshlrev_b32 v12, 4, v12
    v_and_b32 v13, 1, v11
    v_lshl_add_u32 v12, v13, 3, v12
    v_lshl_add_u32 v13, v9, 2, v10
    v_lshl_add_u32 v1, v13, 7, v12
    v_lshl_add_u32 v13, v9, 3, v10
    v_lshl_add_u32 v15, v13, 7, v12
    v_lshrrev_b32 v6, 2, v7
    v_add_u32 v6, s57, v6
    v_mul_u32_u24 v6, 1280, v6
    v_lshl_add_u32 v5, v11, 4, v6
    v_lshl_add_u32 v6, v8, 2, v9
    v_lshlrev_b32 v16, 2, v6
    v_lshrrev_b32 v12, 3, v7
    s_lshl_b32 s42, s24, 3
    v_add_u32 v12, s42, v12
    v_and_b32 v13, 7, v7
    v_bfe_u32 v14, v12, 1, 3
    v_xor_b32 v14, v14, v13
    v_lshlrev_b32 v14, 4, v14
    v_mul_u32_u24 v8, 384, v12
    v_add_u32 v2, v8, v14
    v_bfe_u32 v14, v12, 1, 2
    v_lshlrev_b32 v14, 1, v14
    v_xor_b32 v14, v14, v13
    v_lshlrev_b32 v14, 4, v14
    v_add_u32 v3, v8, v14
    v_bfe_u32 v14, v12, 1, 1
    v_bfe_u32 v9, v12, 3, 1
    v_lshl_or_b32 v14, v9, 1, v14
    v_lshlrev_b32 v14, 1, v14
    v_xor_b32 v14, v14, v13
    v_lshlrev_b32 v14, 4, v14
    v_mul_u32_u24 v8, 12288, v12
    v_add_u32 v4, v8, v14
    v_mov_b32 v6, v7
    v_mov_b32 v7, v16
    s_mov_b32 s38, 1037384597
    s_mov_b32 s39, 1090519040
    s_mov_b32 s34, 1073741824
    s_mul_i32 s26, s59, 184320
    s_add_u32 s27, s26, 20480
    s_add_u32 s28, s26, 40960
    s_mul_i32 s29, s58, 384
    s_lshl_b32 s42, s59, 5
    s_add_u32 s42, s42, s58
    s_mul_i32 s30, s42, 196608
    s_add_u32 s31, s30, 196608
    s_mov_b32 s32, s30
    s_mov_b32 s33, s31
    s_lshr_b32 s43, s60, 4
    s_mul_i32 s54, s43, 96
    s_mul_i32 s43, s58, 3
    s_add_u32 s54, s54, s43
    s_mul_i32 s54, s54, 2304
    s_mul_i32 s43, s59, 144
    s_add_u32 s54, s54, s43
    s_lshl_b32 s54, s54, 7
    s_add_u32 s55, s54, 294912
    s_add_u32 s56, s54, 589824
    s_waitcnt lgkmcnt(0)
    s_mov_b32 s4, s44
    s_and_b32 s5, s45, 65535
    s_mov_b32 s6, 2949120
    s_mov_b32 s7, 131072
    s_mov_b32 s8, s46
    s_and_b32 s9, s47, 65535
    s_mov_b32 s10, 100663296
    s_mov_b32 s11, 131072
    s_mov_b32 s12, s48
    s_and_b32 s13, s49, 65535
    s_mov_b32 s14, 100663296
    s_mov_b32 s15, 131072
    s_mov_b32 s16, s50
    s_and_b32 s17, s51, 65535
    s_mov_b32 s18, 7864320
    s_mov_b32 s19, 131072
    s_mov_b32 s20, s52
    s_and_b32 s21, s53, 65535
    s_mov_b32 s22, 56623104
    s_mov_b32 s23, 131072
    s_cmp_eq_u32 s24, 0
    s_cbranch_scc0 attn_kernel_light
    s_mov_b32 s61, 0
    s_add_u32 s40, s25, 0
    s_add_u32 m0, s40, 0
    s_nop 0
    buffer_load_dwordx4 v4, s[16:19], s29 offen lds
    s_add_u32 m0, s40, 3968
    s_nop 0
    buffer_load_dwordx4 v4, s[16:19], s29 offen offset:128 lds
    s_add_u32 m0, s40, 7936
    s_nop 0
    buffer_load_dwordx4 v4, s[16:19], s29 offen offset:256 lds
    s_add_u32 s29, s29, 393216
    s_add_u32 s40, s25, 12288
    s_add_u32 m0, s40, 0
    s_nop 0
    buffer_load_dwordx4 v4, s[16:19], s29 offen lds
    s_add_u32 m0, s40, 3968
    s_nop 0
    buffer_load_dwordx4 v4, s[16:19], s29 offen offset:128 lds
    s_add_u32 m0, s40, 7936
    s_nop 0
    buffer_load_dwordx4 v4, s[16:19], s29 offen offset:256 lds
    s_add_u32 s29, s29, 393216
    buffer_load_dwordx4 v[40:43], v5, s[4:7], s26 offen
    s_add_u32 s26, s26, 64
    buffer_load_dwordx4 v[44:47], v5, s[4:7], s27 offen
    s_add_u32 s27, s27, 64
    buffer_load_dwordx4 v[48:51], v5, s[4:7], s28 offen
    s_add_u32 s28, s28, 64
    s_add_u32 s61, s61, 1
    s_add_u32 s40, s25, 24576
    s_add_u32 m0, s40, 0
    s_nop 0
    buffer_load_dwordx4 v4, s[16:19], s29 offen lds
    s_add_u32 m0, s40, 3968
    s_nop 0
    buffer_load_dwordx4 v4, s[16:19], s29 offen offset:128 lds
    s_add_u32 m0, s40, 7936
    s_nop 0
    buffer_load_dwordx4 v4, s[16:19], s29 offen offset:256 lds
    s_add_u32 s29, s29, 393216
    buffer_load_dwordx4 v[52:55], v5, s[4:7], s26 offen
    s_add_u32 s26, s26, 64
    buffer_load_dwordx4 v[56:59], v5, s[4:7], s27 offen
    s_add_u32 s27, s27, 64
    buffer_load_dwordx4 v[60:63], v5, s[4:7], s28 offen
    s_add_u32 s28, s28, 64
    s_add_u32 s61, s61, 1
    s_add_u32 s40, s25, 36864
    s_add_u32 m0, s40, 0
    s_nop 0
    buffer_load_dwordx4 v4, s[16:19], s29 offen lds
    s_add_u32 m0, s40, 3968
    s_nop 0
    buffer_load_dwordx4 v4, s[16:19], s29 offen offset:128 lds
    s_add_u32 m0, s40, 7936
    s_nop 0
    buffer_load_dwordx4 v4, s[16:19], s29 offen offset:256 lds
    s_add_u32 s29, s29, 393216
    buffer_load_dwordx4 v[64:67], v5, s[4:7], s26 offen
    s_add_u32 s26, s26, 64
    buffer_load_dwordx4 v[68:71], v5, s[4:7], s27 offen
    s_add_u32 s27, s27, 64
    buffer_load_dwordx4 v[72:75], v5, s[4:7], s28 offen
    s_add_u32 s28, s28, 64
    s_add_u32 s61, s61, 1
    s_add_u32 s40, s25, 49152
    s_add_u32 m0, s40, 0
    s_nop 0
    buffer_load_dwordx4 v4, s[16:19], s29 offen lds
    s_add_u32 m0, s40, 3968
    s_nop 0
    buffer_load_dwordx4 v4, s[16:19], s29 offen offset:128 lds
    s_add_u32 m0, s40, 7936
    s_nop 0
    buffer_load_dwordx4 v4, s[16:19], s29 offen offset:256 lds
    s_add_u32 s29, s29, 393216
    v_mov_b32 v112, 0
    v_mov_b32 v113, 0
    v_mov_b32 v114, 0
    v_mov_b32 v115, 0
    v_mov_b32 v116, 0
    v_mov_b32 v117, 0
    v_mov_b32 v118, 0
    v_mov_b32 v119, 0
    v_mov_b32 v120, 0
    v_mov_b32 v121, 0
    v_mov_b32 v122, 0
    v_mov_b32 v123, 0
    v_mov_b32 v124, 0
    v_mov_b32 v125, 0
    v_mov_b32 v126, 0
    v_mov_b32 v127, 0
    v_mov_b32 v128, 0
    v_mov_b32 v129, 0
    v_mov_b32 v130, 0
    v_mov_b32 v131, 0
    v_mov_b32 v132, 0
    v_mov_b32 v133, 0
    v_mov_b32 v134, 0
    v_mov_b32 v135, 0
    v_mov_b32 v136, 0
    v_mov_b32 v137, 0
    v_mov_b32 v138, 0
    v_mov_b32 v139, 0
    v_mov_b32 v140, 0
    v_mov_b32 v141, 0
    v_mov_b32 v142, 0
    v_mov_b32 v143, 0
    v_mov_b32 v144, 0
    v_mov_b32 v145, 0
    v_mov_b32 v146, 0
    v_mov_b32 v147, 0
    v_mov_b32 v148, 0
    v_mov_b32 v149, 0
    v_mov_b32 v150, 0
    v_mov_b32 v151, 0
    v_mov_b32 v152, 0
    v_mov_b32 v153, 0
    v_mov_b32 v154, 0
    v_mov_b32 v155, 0
    v_mov_b32 v156, 0
    v_mov_b32 v157, 0
    v_mov_b32 v158, 0
    v_mov_b32 v159, 0
    v_mov_b32 v160, 0
    v_mov_b32 v161, 0
    v_mov_b32 v162, 0
    v_mov_b32 v163, 0
    v_mov_b32 v164, 0
    v_mov_b32 v165, 0
    v_mov_b32 v166, 0
    v_mov_b32 v167, 0
    v_mov_b32 v168, 0
    v_mov_b32 v169, 0
    v_mov_b32 v170, 0
    v_mov_b32 v171, 0
    v_mov_b32 v172, 0
    v_mov_b32 v173, 0
    v_mov_b32 v174, 0
    v_mov_b32 v175, 0
    v_mov_b32 v176, 0
    v_mov_b32 v177, 0
    v_mov_b32 v178, 0
    v_mov_b32 v179, 0
    v_mov_b32 v180, 0
    v_mov_b32 v181, 0
    v_mov_b32 v182, 0
    v_mov_b32 v183, 0
    v_mov_b32 v184, 0
    v_mov_b32 v185, 0
    v_mov_b32 v186, 0
    v_mov_b32 v187, 0
    v_mov_b32 v188, 0
    v_mov_b32 v189, 0
    v_mov_b32 v190, 0
    v_mov_b32 v191, 0
    v_mov_b32 v192, 0
    v_mov_b32 v193, 0
    v_mov_b32 v194, 0
    v_mov_b32 v195, 0
    v_mov_b32 v196, 0
    v_mov_b32 v197, 0
    v_mov_b32 v198, 0
    v_mov_b32 v199, 0
    v_mov_b32 v200, 0
    v_mov_b32 v201, 0
    v_mov_b32 v202, 0
    v_mov_b32 v203, 0
    v_mov_b32 v204, 0
    v_mov_b32 v205, 0
    v_mov_b32 v206, 0
    v_mov_b32 v207, 0
    v_mov_b32 v208, 0
    v_mov_b32 v209, 0
    v_mov_b32 v210, 0
    v_mov_b32 v211, 0
    v_mov_b32 v212, 0
    v_mov_b32 v213, 0
    v_mov_b32 v214, 0
    v_mov_b32 v215, 0
    v_mov_b32 v216, 0
    v_mov_b32 v217, 0
    v_mov_b32 v218, 0
    v_mov_b32 v219, 0
    v_mov_b32 v220, 0
    v_mov_b32 v221, 0
    v_mov_b32 v222, 0
    v_mov_b32 v223, 0
    v_mov_b32 v224, 0
    v_mov_b32 v225, 0
    v_mov_b32 v226, 0
    v_mov_b32 v227, 0
    v_mov_b32 v228, 0
    v_mov_b32 v229, 0
    v_mov_b32 v230, 0
    v_mov_b32 v231, 0
    v_mov_b32 v232, 0
    v_mov_b32 v233, 0
    v_mov_b32 v234, 0
    v_mov_b32 v235, 0
    v_mov_b32 v236, 0
    v_mov_b32 v237, 0
    v_mov_b32 v238, 0
    v_mov_b32 v239, 0
    v_mov_b32 v240, 0
    v_mov_b32 v241, 0
    v_mov_b32 v242, 0
    v_mov_b32 v243, 0
    v_mov_b32 v244, 0
    v_mov_b32 v245, 0
    v_mov_b32 v246, 0
    v_mov_b32 v247, 0
    v_mov_b32 v248, 0
    v_mov_b32 v249, 0
    v_mov_b32 v250, 0
    v_mov_b32 v251, 0
    v_mov_b32 v252, 0
    v_mov_b32 v253, 0
    v_mov_b32 v254, 0
    v_mov_b32 v255, 0
    s_mov_b32 s3, 5
    s_mov_b32 s35, 0
    s_add_u32 s36, s25, 61440
    s_mov_b32 s37, 0
    s_nop 3
attn_kernel_h_qloop:
    s_waitcnt vmcnt(9)
    s_barrier
    s_cmp_lt_u32 s3, 20
    s_cbranch_scc0 attn_kernel_h_kv_4
    s_mov_b64 s[92:93], s[16:17]
    s_mov_b64 s[94:95], s[18:19]
    s_mov_b32 s96, s29
    v_mov_b32 v9, v4
    s_add_u32 s29, s29, 393216
    s_branch attn_kernel_h_dn_6
attn_kernel_h_kv_4:
    s_bitcmp1_b32 s3, 0
    s_cbranch_scc1 attn_kernel_h_v_5
    s_mov_b64 s[92:93], s[8:9]
    s_mov_b64 s[94:95], s[10:11]
    s_mov_b32 s96, s30
    v_mov_b32 v9, v2
    s_add_u32 s30, s30, 12288
    s_branch attn_kernel_h_dn_6
attn_kernel_h_v_5:
    s_mov_b64 s[92:93], s[12:13]
    s_mov_b64 s[94:95], s[14:15]
    s_mov_b32 s96, s32
    v_mov_b32 v9, v3
    s_add_u32 s32, s32, 12288
attn_kernel_h_dn_6:
    s_add_u32 s3, s3, 1
    v_add_u32 v11, s35, v15
    v_xor_b32 v12, 32, v11
    v_xor_b32 v13, 64, v11
    v_xor_b32 v14, 96, v11
    ds_bpermute_b32 v88, v7, v40
    ds_bpermute_b32 v89, v7, v41
    ds_bpermute_b32 v90, v7, v42
    ds_bpermute_b32 v91, v7, v43
    ds_bpermute_b32 v92, v7, v44
    ds_bpermute_b32 v93, v7, v45
    ds_bpermute_b32 v94, v7, v46
    ds_bpermute_b32 v95, v7, v47
    ds_bpermute_b32 v96, v7, v48
    ds_bpermute_b32 v97, v7, v49
    ds_bpermute_b32 v98, v7, v50
    ds_bpermute_b32 v99, v7, v51
    ds_read_b64_tr_b16 v[16:17], v11
    ds_read_b64_tr_b16 v[18:19], v11 offset:512
    ds_read_b64_tr_b16 v[20:21], v12
    ds_read_b64_tr_b16 v[22:23], v12 offset:512
    ds_read_b64_tr_b16 v[24:25], v13
    ds_read_b64_tr_b16 v[26:27], v13 offset:512
    ds_read_b64_tr_b16 v[28:29], v14
    ds_read_b64_tr_b16 v[30:31], v14 offset:512
    ds_read_b64_tr_b16 v[32:33], v11 offset:4096
    ds_read_b64_tr_b16 v[34:35], v11 offset:4608
    s_waitcnt lgkmcnt(8)
    v_mfma_f32_16x16x32_bf16 v[112:115], v[16:19], v[88:91], v[112:115]
    v_mfma_f32_16x16x32_bf16 v[116:119], v[16:19], v[92:95], v[116:119]
    v_mfma_f32_16x16x32_bf16 v[120:123], v[16:19], v[96:99], v[120:123]
    ds_read_b64_tr_b16 v[36:37], v12 offset:4096
    ds_read_b64_tr_b16 v[38:39], v12 offset:4608
    s_waitcnt lgkmcnt(8)
    v_mfma_f32_16x16x32_bf16 v[124:127], v[20:23], v[88:91], v[124:127]
    v_mfma_f32_16x16x32_bf16 v[128:131], v[20:23], v[92:95], v[128:131]
    v_mfma_f32_16x16x32_bf16 v[132:135], v[20:23], v[96:99], v[132:135]
    s_cmp_lt_u32 s61, 20
    s_cbranch_scc0 attn_kernel_h_nx_7
    buffer_load_dwordx4 v[76:79], v5, s[4:7], s26 offen
    s_add_u32 s26, s26, 64
    buffer_load_dwordx4 v[80:83], v5, s[4:7], s27 offen
    s_add_u32 s27, s27, 64
    buffer_load_dwordx4 v[84:87], v5, s[4:7], s28 offen
    s_add_u32 s28, s28, 64
    s_add_u32 s61, s61, 1
attn_kernel_h_nx_7:
    ds_read_b64_tr_b16 v[16:17], v13 offset:4096
    ds_read_b64_tr_b16 v[18:19], v13 offset:4608
    s_waitcnt lgkmcnt(8)
    v_mfma_f32_16x16x32_bf16 v[136:139], v[24:27], v[88:91], v[136:139]
    v_mfma_f32_16x16x32_bf16 v[140:143], v[24:27], v[92:95], v[140:143]
    v_mfma_f32_16x16x32_bf16 v[144:147], v[24:27], v[96:99], v[144:147]
    ds_read_b64_tr_b16 v[20:21], v14 offset:4096
    ds_read_b64_tr_b16 v[22:23], v14 offset:4608
    s_waitcnt lgkmcnt(8)
    v_mfma_f32_16x16x32_bf16 v[148:151], v[28:31], v[88:91], v[148:151]
    v_mfma_f32_16x16x32_bf16 v[152:155], v[28:31], v[92:95], v[152:155]
    v_mfma_f32_16x16x32_bf16 v[156:159], v[28:31], v[96:99], v[156:159]
    ds_read_b64_tr_b16 v[24:25], v11 offset:8192
    ds_read_b64_tr_b16 v[26:27], v11 offset:8704
    s_waitcnt lgkmcnt(8)
    v_mfma_f32_16x16x32_bf16 v[160:163], v[32:35], v[88:91], v[160:163]
    v_mfma_f32_16x16x32_bf16 v[164:167], v[32:35], v[92:95], v[164:167]
    v_mfma_f32_16x16x32_bf16 v[168:171], v[32:35], v[96:99], v[168:171]
    s_add_u32 m0, s36, 0
    s_nop 0
    buffer_load_dwordx4 v9, s[92:95], s96 offen lds
    ds_read_b64_tr_b16 v[28:29], v12 offset:8192
    ds_read_b64_tr_b16 v[30:31], v12 offset:8704
    s_waitcnt lgkmcnt(8)
    v_mfma_f32_16x16x32_bf16 v[172:175], v[36:39], v[88:91], v[172:175]
    v_mfma_f32_16x16x32_bf16 v[176:179], v[36:39], v[92:95], v[176:179]
    v_mfma_f32_16x16x32_bf16 v[180:183], v[36:39], v[96:99], v[180:183]
    ds_read_b64_tr_b16 v[32:33], v13 offset:8192
    ds_read_b64_tr_b16 v[34:35], v13 offset:8704
    s_waitcnt lgkmcnt(8)
    v_mfma_f32_16x16x32_bf16 v[184:187], v[16:19], v[88:91], v[184:187]
    v_mfma_f32_16x16x32_bf16 v[188:191], v[16:19], v[92:95], v[188:191]
    v_mfma_f32_16x16x32_bf16 v[192:195], v[16:19], v[96:99], v[192:195]
    s_add_u32 m0, s36, 3968
    s_nop 0
    buffer_load_dwordx4 v9, s[92:95], s96 offen offset:128 lds
    ds_read_b64_tr_b16 v[36:37], v14 offset:8192
    ds_read_b64_tr_b16 v[38:39], v14 offset:8704
    s_waitcnt lgkmcnt(8)
    v_mfma_f32_16x16x32_bf16 v[196:199], v[20:23], v[88:91], v[196:199]
    v_mfma_f32_16x16x32_bf16 v[200:203], v[20:23], v[92:95], v[200:203]
    v_mfma_f32_16x16x32_bf16 v[204:207], v[20:23], v[96:99], v[204:207]
    s_waitcnt lgkmcnt(6)
    v_mfma_f32_16x16x32_bf16 v[208:211], v[24:27], v[88:91], v[208:211]
    v_mfma_f32_16x16x32_bf16 v[212:215], v[24:27], v[92:95], v[212:215]
    v_mfma_f32_16x16x32_bf16 v[216:219], v[24:27], v[96:99], v[216:219]
    s_add_u32 m0, s36, 7936
    s_nop 0
    buffer_load_dwordx4 v9, s[92:95], s96 offen offset:256 lds
    s_waitcnt lgkmcnt(4)
    v_mfma_f32_16x16x32_bf16 v[220:223], v[28:31], v[88:91], v[220:223]
    v_mfma_f32_16x16x32_bf16 v[224:227], v[28:31], v[92:95], v[224:227]
    v_mfma_f32_16x16x32_bf16 v[228:231], v[28:31], v[96:99], v[228:231]
    s_waitcnt lgkmcnt(2)
    v_mfma_f32_16x16x32_bf16 v[232:235], v[32:35], v[88:91], v[232:235]
    v_mfma_f32_16x16x32_bf16 v[236:239], v[32:35], v[92:95], v[236:239]
    v_mfma_f32_16x16x32_bf16 v[240:243], v[32:35], v[96:99], v[240:243]
    s_waitcnt lgkmcnt(0)
    v_mfma_f32_16x16x32_bf16 v[244:247], v[36:39], v[88:91], v[244:247]
    v_mfma_f32_16x16x32_bf16 v[248:251], v[36:39], v[92:95], v[248:251]
    v_mfma_f32_16x16x32_bf16 v[252:255], v[36:39], v[96:99], v[252:255]
    s_add_u32 s36, s35, s25
    s_add_u32 s35, s35, 12288
    s_cmp_eq_u32 s35, 73728
    s_cselect_b32 s35, 0, s35
    s_waitcnt vmcnt(9)
    s_barrier
    s_cmp_lt_u32 s3, 20
    s_cbranch_scc0 attn_kernel_h_kv_8
    s_mov_b64 s[92:93], s[16:17]
    s_mov_b64 s[94:95], s[18:19]
    s_mov_b32 s96, s29
    v_mov_b32 v9, v4
    s_add_u32 s29, s29, 393216
    s_branch attn_kernel_h_dn_10
attn_kernel_h_kv_8:
    s_bitcmp1_b32 s3, 0
    s_cbranch_scc1 attn_kernel_h_v_9
    s_mov_b64 s[92:93], s[8:9]
    s_mov_b64 s[94:95], s[10:11]
    s_mov_b32 s96, s30
    v_mov_b32 v9, v2
    s_add_u32 s30, s30, 12288
    s_branch attn_kernel_h_dn_10
attn_kernel_h_v_9:
    s_mov_b64 s[92:93], s[12:13]
    s_mov_b64 s[94:95], s[14:15]
    s_mov_b32 s96, s32
    v_mov_b32 v9, v3
    s_add_u32 s32, s32, 12288
attn_kernel_h_dn_10:
    s_add_u32 s3, s3, 1
    v_add_u32 v11, s35, v15
    v_xor_b32 v12, 32, v11
    v_xor_b32 v13, 64, v11
    v_xor_b32 v14, 96, v11
    ds_bpermute_b32 v88, v7, v52
    ds_bpermute_b32 v89, v7, v53
    ds_bpermute_b32 v90, v7, v54
    ds_bpermute_b32 v91, v7, v55
    ds_bpermute_b32 v92, v7, v56
    ds_bpermute_b32 v93, v7, v57
    ds_bpermute_b32 v94, v7, v58
    ds_bpermute_b32 v95, v7, v59
    ds_bpermute_b32 v96, v7, v60
    ds_bpermute_b32 v97, v7, v61
    ds_bpermute_b32 v98, v7, v62
    ds_bpermute_b32 v99, v7, v63
    ds_read_b64_tr_b16 v[16:17], v11
    ds_read_b64_tr_b16 v[18:19], v11 offset:512
    ds_read_b64_tr_b16 v[20:21], v12
    ds_read_b64_tr_b16 v[22:23], v12 offset:512
    ds_read_b64_tr_b16 v[24:25], v13
    ds_read_b64_tr_b16 v[26:27], v13 offset:512
    ds_read_b64_tr_b16 v[28:29], v14
    ds_read_b64_tr_b16 v[30:31], v14 offset:512
    ds_read_b64_tr_b16 v[32:33], v11 offset:4096
    ds_read_b64_tr_b16 v[34:35], v11 offset:4608
    s_waitcnt lgkmcnt(8)
    v_mfma_f32_16x16x32_bf16 v[112:115], v[16:19], v[88:91], v[112:115]
    v_mfma_f32_16x16x32_bf16 v[116:119], v[16:19], v[92:95], v[116:119]
    v_mfma_f32_16x16x32_bf16 v[120:123], v[16:19], v[96:99], v[120:123]
    ds_read_b64_tr_b16 v[36:37], v12 offset:4096
    ds_read_b64_tr_b16 v[38:39], v12 offset:4608
    s_waitcnt lgkmcnt(8)
    v_mfma_f32_16x16x32_bf16 v[124:127], v[20:23], v[88:91], v[124:127]
    v_mfma_f32_16x16x32_bf16 v[128:131], v[20:23], v[92:95], v[128:131]
    v_mfma_f32_16x16x32_bf16 v[132:135], v[20:23], v[96:99], v[132:135]
    s_cmp_lt_u32 s61, 20
    s_cbranch_scc0 attn_kernel_h_nx_11
    buffer_load_dwordx4 v[40:43], v5, s[4:7], s26 offen
    s_add_u32 s26, s26, 64
    buffer_load_dwordx4 v[44:47], v5, s[4:7], s27 offen
    s_add_u32 s27, s27, 64
    buffer_load_dwordx4 v[48:51], v5, s[4:7], s28 offen
    s_add_u32 s28, s28, 64
    s_add_u32 s61, s61, 1
attn_kernel_h_nx_11:
    ds_read_b64_tr_b16 v[16:17], v13 offset:4096
    ds_read_b64_tr_b16 v[18:19], v13 offset:4608
    s_waitcnt lgkmcnt(8)
    v_mfma_f32_16x16x32_bf16 v[136:139], v[24:27], v[88:91], v[136:139]
    v_mfma_f32_16x16x32_bf16 v[140:143], v[24:27], v[92:95], v[140:143]
    v_mfma_f32_16x16x32_bf16 v[144:147], v[24:27], v[96:99], v[144:147]
    ds_read_b64_tr_b16 v[20:21], v14 offset:4096
    ds_read_b64_tr_b16 v[22:23], v14 offset:4608
    s_waitcnt lgkmcnt(8)
    v_mfma_f32_16x16x32_bf16 v[148:151], v[28:31], v[88:91], v[148:151]
    v_mfma_f32_16x16x32_bf16 v[152:155], v[28:31], v[92:95], v[152:155]
    v_mfma_f32_16x16x32_bf16 v[156:159], v[28:31], v[96:99], v[156:159]
    ds_read_b64_tr_b16 v[24:25], v11 offset:8192
    ds_read_b64_tr_b16 v[26:27], v11 offset:8704
    s_waitcnt lgkmcnt(8)
    v_mfma_f32_16x16x32_bf16 v[160:163], v[32:35], v[88:91], v[160:163]
    v_mfma_f32_16x16x32_bf16 v[164:167], v[32:35], v[92:95], v[164:167]
    v_mfma_f32_16x16x32_bf16 v[168:171], v[32:35], v[96:99], v[168:171]
    s_add_u32 m0, s36, 0
    s_nop 0
    buffer_load_dwordx4 v9, s[92:95], s96 offen lds
    ds_read_b64_tr_b16 v[28:29], v12 offset:8192
    ds_read_b64_tr_b16 v[30:31], v12 offset:8704
    s_waitcnt lgkmcnt(8)
    v_mfma_f32_16x16x32_bf16 v[172:175], v[36:39], v[88:91], v[172:175]
    v_mfma_f32_16x16x32_bf16 v[176:179], v[36:39], v[92:95], v[176:179]
    v_mfma_f32_16x16x32_bf16 v[180:183], v[36:39], v[96:99], v[180:183]
    ds_read_b64_tr_b16 v[32:33], v13 offset:8192
    ds_read_b64_tr_b16 v[34:35], v13 offset:8704
    s_waitcnt lgkmcnt(8)
    v_mfma_f32_16x16x32_bf16 v[184:187], v[16:19], v[88:91], v[184:187]
    v_mfma_f32_16x16x32_bf16 v[188:191], v[16:19], v[92:95], v[188:191]
    v_mfma_f32_16x16x32_bf16 v[192:195], v[16:19], v[96:99], v[192:195]
    s_add_u32 m0, s36, 3968
    s_nop 0
    buffer_load_dwordx4 v9, s[92:95], s96 offen offset:128 lds
    ds_read_b64_tr_b16 v[36:37], v14 offset:8192
    ds_read_b64_tr_b16 v[38:39], v14 offset:8704
    s_waitcnt lgkmcnt(8)
    v_mfma_f32_16x16x32_bf16 v[196:199], v[20:23], v[88:91], v[196:199]
    v_mfma_f32_16x16x32_bf16 v[200:203], v[20:23], v[92:95], v[200:203]
    v_mfma_f32_16x16x32_bf16 v[204:207], v[20:23], v[96:99], v[204:207]
    s_waitcnt lgkmcnt(6)
    v_mfma_f32_16x16x32_bf16 v[208:211], v[24:27], v[88:91], v[208:211]
    v_mfma_f32_16x16x32_bf16 v[212:215], v[24:27], v[92:95], v[212:215]
    v_mfma_f32_16x16x32_bf16 v[216:219], v[24:27], v[96:99], v[216:219]
    s_add_u32 m0, s36, 7936
    s_nop 0
    buffer_load_dwordx4 v9, s[92:95], s96 offen offset:256 lds
    s_waitcnt lgkmcnt(4)
    v_mfma_f32_16x16x32_bf16 v[220:223], v[28:31], v[88:91], v[220:223]
    v_mfma_f32_16x16x32_bf16 v[224:227], v[28:31], v[92:95], v[224:227]
    v_mfma_f32_16x16x32_bf16 v[228:231], v[28:31], v[96:99], v[228:231]
    s_waitcnt lgkmcnt(2)
    v_mfma_f32_16x16x32_bf16 v[232:235], v[32:35], v[88:91], v[232:235]
    v_mfma_f32_16x16x32_bf16 v[236:239], v[32:35], v[92:95], v[236:239]
    v_mfma_f32_16x16x32_bf16 v[240:243], v[32:35], v[96:99], v[240:243]
    s_waitcnt lgkmcnt(0)
    v_mfma_f32_16x16x32_bf16 v[244:247], v[36:39], v[88:91], v[244:247]
    v_mfma_f32_16x16x32_bf16 v[248:251], v[36:39], v[92:95], v[248:251]
    v_mfma_f32_16x16x32_bf16 v[252:255], v[36:39], v[96:99], v[252:255]
    s_add_u32 s36, s35, s25
    s_add_u32 s35, s35, 12288
    s_cmp_eq_u32 s35, 73728
    s_cselect_b32 s35, 0, s35
    s_waitcnt vmcnt(9)
    s_barrier
    s_cmp_lt_u32 s3, 20
    s_cbranch_scc0 attn_kernel_h_kv_12
    s_mov_b64 s[92:93], s[16:17]
    s_mov_b64 s[94:95], s[18:19]
    s_mov_b32 s96, s29
    v_mov_b32 v9, v4
    s_add_u32 s29, s29, 393216
    s_branch attn_kernel_h_dn_14
attn_kernel_h_kv_12:
    s_bitcmp1_b32 s3, 0
    s_cbranch_scc1 attn_kernel_h_v_13
    s_mov_b64 s[92:93], s[8:9]
    s_mov_b64 s[94:95], s[10:11]
    s_mov_b32 s96, s30
    v_mov_b32 v9, v2
    s_add_u32 s30, s30, 12288
    s_branch attn_kernel_h_dn_14
attn_kernel_h_v_13:
    s_mov_b64 s[92:93], s[12:13]
    s_mov_b64 s[94:95], s[14:15]
    s_mov_b32 s96, s32
    v_mov_b32 v9, v3
    s_add_u32 s32, s32, 12288
attn_kernel_h_dn_14:
    s_add_u32 s3, s3, 1
    v_add_u32 v11, s35, v15
    v_xor_b32 v12, 32, v11
    v_xor_b32 v13, 64, v11
    v_xor_b32 v14, 96, v11
    ds_bpermute_b32 v88, v7, v64
    ds_bpermute_b32 v89, v7, v65
    ds_bpermute_b32 v90, v7, v66
    ds_bpermute_b32 v91, v7, v67
    ds_bpermute_b32 v92, v7, v68
    ds_bpermute_b32 v93, v7, v69
    ds_bpermute_b32 v94, v7, v70
    ds_bpermute_b32 v95, v7, v71
    ds_bpermute_b32 v96, v7, v72
    ds_bpermute_b32 v97, v7, v73
    ds_bpermute_b32 v98, v7, v74
    ds_bpermute_b32 v99, v7, v75
    ds_read_b64_tr_b16 v[16:17], v11
    ds_read_b64_tr_b16 v[18:19], v11 offset:512
    ds_read_b64_tr_b16 v[20:21], v12
    ds_read_b64_tr_b16 v[22:23], v12 offset:512
    ds_read_b64_tr_b16 v[24:25], v13
    ds_read_b64_tr_b16 v[26:27], v13 offset:512
    ds_read_b64_tr_b16 v[28:29], v14
    ds_read_b64_tr_b16 v[30:31], v14 offset:512
    ds_read_b64_tr_b16 v[32:33], v11 offset:4096
    ds_read_b64_tr_b16 v[34:35], v11 offset:4608
    s_waitcnt lgkmcnt(8)
    v_mfma_f32_16x16x32_bf16 v[112:115], v[16:19], v[88:91], v[112:115]
    v_mfma_f32_16x16x32_bf16 v[116:119], v[16:19], v[92:95], v[116:119]
    v_mfma_f32_16x16x32_bf16 v[120:123], v[16:19], v[96:99], v[120:123]
    ds_read_b64_tr_b16 v[36:37], v12 offset:4096
    ds_read_b64_tr_b16 v[38:39], v12 offset:4608
    s_waitcnt lgkmcnt(8)
    v_mfma_f32_16x16x32_bf16 v[124:127], v[20:23], v[88:91], v[124:127]
    v_mfma_f32_16x16x32_bf16 v[128:131], v[20:23], v[92:95], v[128:131]
    v_mfma_f32_16x16x32_bf16 v[132:135], v[20:23], v[96:99], v[132:135]
    s_cmp_lt_u32 s61, 20
    s_cbranch_scc0 attn_kernel_h_nx_15
    buffer_load_dwordx4 v[52:55], v5, s[4:7], s26 offen
    s_add_u32 s26, s26, 64
    buffer_load_dwordx4 v[56:59], v5, s[4:7], s27 offen
    s_add_u32 s27, s27, 64
    buffer_load_dwordx4 v[60:63], v5, s[4:7], s28 offen
    s_add_u32 s28, s28, 64
    s_add_u32 s61, s61, 1
attn_kernel_h_nx_15:
    ds_read_b64_tr_b16 v[16:17], v13 offset:4096
    ds_read_b64_tr_b16 v[18:19], v13 offset:4608
    s_waitcnt lgkmcnt(8)
    v_mfma_f32_16x16x32_bf16 v[136:139], v[24:27], v[88:91], v[136:139]
    v_mfma_f32_16x16x32_bf16 v[140:143], v[24:27], v[92:95], v[140:143]
    v_mfma_f32_16x16x32_bf16 v[144:147], v[24:27], v[96:99], v[144:147]
    ds_read_b64_tr_b16 v[20:21], v14 offset:4096
    ds_read_b64_tr_b16 v[22:23], v14 offset:4608
    s_waitcnt lgkmcnt(8)
    v_mfma_f32_16x16x32_bf16 v[148:151], v[28:31], v[88:91], v[148:151]
    v_mfma_f32_16x16x32_bf16 v[152:155], v[28:31], v[92:95], v[152:155]
    v_mfma_f32_16x16x32_bf16 v[156:159], v[28:31], v[96:99], v[156:159]
    ds_read_b64_tr_b16 v[24:25], v11 offset:8192
    ds_read_b64_tr_b16 v[26:27], v11 offset:8704
    s_waitcnt lgkmcnt(8)
    v_mfma_f32_16x16x32_bf16 v[160:163], v[32:35], v[88:91], v[160:163]
    v_mfma_f32_16x16x32_bf16 v[164:167], v[32:35], v[92:95], v[164:167]
    v_mfma_f32_16x16x32_bf16 v[168:171], v[32:35], v[96:99], v[168:171]
    s_add_u32 m0, s36, 0
    s_nop 0
    buffer_load_dwordx4 v9, s[92:95], s96 offen lds
    ds_read_b64_tr_b16 v[28:29], v12 offset:8192
    ds_read_b64_tr_b16 v[30:31], v12 offset:8704
    s_waitcnt lgkmcnt(8)
    v_mfma_f32_16x16x32_bf16 v[172:175], v[36:39], v[88:91], v[172:175]
    v_mfma_f32_16x16x32_bf16 v[176:179], v[36:39], v[92:95], v[176:179]
    v_mfma_f32_16x16x32_bf16 v[180:183], v[36:39], v[96:99], v[180:183]
    ds_read_b64_tr_b16 v[32:33], v13 offset:8192
    ds_read_b64_tr_b16 v[34:35], v13 offset:8704
    s_waitcnt lgkmcnt(8)
    v_mfma_f32_16x16x32_bf16 v[184:187], v[16:19], v[88:91], v[184:187]
    v_mfma_f32_16x16x32_bf16 v[188:191], v[16:19], v[92:95], v[188:191]
    v_mfma_f32_16x16x32_bf16 v[192:195], v[16:19], v[96:99], v[192:195]
    s_add_u32 m0, s36, 3968
    s_nop 0
    buffer_load_dwordx4 v9, s[92:95], s96 offen offset:128 lds
    ds_read_b64_tr_b16 v[36:37], v14 offset:8192
    ds_read_b64_tr_b16 v[38:39], v14 offset:8704
    s_waitcnt lgkmcnt(8)
    v_mfma_f32_16x16x32_bf16 v[196:199], v[20:23], v[88:91], v[196:199]
    v_mfma_f32_16x16x32_bf16 v[200:203], v[20:23], v[92:95], v[200:203]
    v_mfma_f32_16x16x32_bf16 v[204:207], v[20:23], v[96:99], v[204:207]
    s_waitcnt lgkmcnt(6)
    v_mfma_f32_16x16x32_bf16 v[208:211], v[24:27], v[88:91], v[208:211]
    v_mfma_f32_16x16x32_bf16 v[212:215], v[24:27], v[92:95], v[212:215]
    v_mfma_f32_16x16x32_bf16 v[216:219], v[24:27], v[96:99], v[216:219]
    s_add_u32 m0, s36, 7936
    s_nop 0
    buffer_load_dwordx4 v9, s[92:95], s96 offen offset:256 lds
    s_waitcnt lgkmcnt(4)
    v_mfma_f32_16x16x32_bf16 v[220:223], v[28:31], v[88:91], v[220:223]
    v_mfma_f32_16x16x32_bf16 v[224:227], v[28:31], v[92:95], v[224:227]
    v_mfma_f32_16x16x32_bf16 v[228:231], v[28:31], v[96:99], v[228:231]
    s_waitcnt lgkmcnt(2)
    v_mfma_f32_16x16x32_bf16 v[232:235], v[32:35], v[88:91], v[232:235]
    v_mfma_f32_16x16x32_bf16 v[236:239], v[32:35], v[92:95], v[236:239]
    v_mfma_f32_16x16x32_bf16 v[240:243], v[32:35], v[96:99], v[240:243]
    s_waitcnt lgkmcnt(0)
    v_mfma_f32_16x16x32_bf16 v[244:247], v[36:39], v[88:91], v[244:247]
    v_mfma_f32_16x16x32_bf16 v[248:251], v[36:39], v[92:95], v[248:251]
    v_mfma_f32_16x16x32_bf16 v[252:255], v[36:39], v[96:99], v[252:255]
    s_add_u32 s36, s35, s25
    s_add_u32 s35, s35, 12288
    s_cmp_eq_u32 s35, 73728
    s_cselect_b32 s35, 0, s35
    s_waitcnt vmcnt(9)
    s_barrier
    s_cmp_lt_u32 s3, 20
    s_cbranch_scc0 attn_kernel_h_kv_16
    s_mov_b64 s[92:93], s[16:17]
    s_mov_b64 s[94:95], s[18:19]
    s_mov_b32 s96, s29
    v_mov_b32 v9, v4
    s_add_u32 s29, s29, 393216
    s_branch attn_kernel_h_dn_18
attn_kernel_h_kv_16:
    s_bitcmp1_b32 s3, 0
    s_cbranch_scc1 attn_kernel_h_v_17
    s_mov_b64 s[92:93], s[8:9]
    s_mov_b64 s[94:95], s[10:11]
    s_mov_b32 s96, s30
    v_mov_b32 v9, v2
    s_add_u32 s30, s30, 12288
    s_branch attn_kernel_h_dn_18
attn_kernel_h_v_17:
    s_mov_b64 s[92:93], s[12:13]
    s_mov_b64 s[94:95], s[14:15]
    s_mov_b32 s96, s32
    v_mov_b32 v9, v3
    s_add_u32 s32, s32, 12288
attn_kernel_h_dn_18:
    s_add_u32 s3, s3, 1
    v_add_u32 v11, s35, v15
    v_xor_b32 v12, 32, v11
    v_xor_b32 v13, 64, v11
    v_xor_b32 v14, 96, v11
    ds_bpermute_b32 v88, v7, v76
    ds_bpermute_b32 v89, v7, v77
    ds_bpermute_b32 v90, v7, v78
    ds_bpermute_b32 v91, v7, v79
    ds_bpermute_b32 v92, v7, v80
    ds_bpermute_b32 v93, v7, v81
    ds_bpermute_b32 v94, v7, v82
    ds_bpermute_b32 v95, v7, v83
    ds_bpermute_b32 v96, v7, v84
    ds_bpermute_b32 v97, v7, v85
    ds_bpermute_b32 v98, v7, v86
    ds_bpermute_b32 v99, v7, v87
    ds_read_b64_tr_b16 v[16:17], v11
    ds_read_b64_tr_b16 v[18:19], v11 offset:512
    ds_read_b64_tr_b16 v[20:21], v12
    ds_read_b64_tr_b16 v[22:23], v12 offset:512
    ds_read_b64_tr_b16 v[24:25], v13
    ds_read_b64_tr_b16 v[26:27], v13 offset:512
    ds_read_b64_tr_b16 v[28:29], v14
    ds_read_b64_tr_b16 v[30:31], v14 offset:512
    ds_read_b64_tr_b16 v[32:33], v11 offset:4096
    ds_read_b64_tr_b16 v[34:35], v11 offset:4608
    s_waitcnt lgkmcnt(8)
    v_mfma_f32_16x16x32_bf16 v[112:115], v[16:19], v[88:91], v[112:115]
    v_mfma_f32_16x16x32_bf16 v[116:119], v[16:19], v[92:95], v[116:119]
    v_mfma_f32_16x16x32_bf16 v[120:123], v[16:19], v[96:99], v[120:123]
    ds_read_b64_tr_b16 v[36:37], v12 offset:4096
    ds_read_b64_tr_b16 v[38:39], v12 offset:4608
    s_waitcnt lgkmcnt(8)
    v_mfma_f32_16x16x32_bf16 v[124:127], v[20:23], v[88:91], v[124:127]
    v_mfma_f32_16x16x32_bf16 v[128:131], v[20:23], v[92:95], v[128:131]
    v_mfma_f32_16x16x32_bf16 v[132:135], v[20:23], v[96:99], v[132:135]
    s_cmp_lt_u32 s61, 20
    s_cbranch_scc0 attn_kernel_h_nx_19
    buffer_load_dwordx4 v[64:67], v5, s[4:7], s26 offen
    s_add_u32 s26, s26, 64
    buffer_load_dwordx4 v[68:71], v5, s[4:7], s27 offen
    s_add_u32 s27, s27, 64
    buffer_load_dwordx4 v[72:75], v5, s[4:7], s28 offen
    s_add_u32 s28, s28, 64
    s_add_u32 s61, s61, 1
attn_kernel_h_nx_19:
    ds_read_b64_tr_b16 v[16:17], v13 offset:4096
    ds_read_b64_tr_b16 v[18:19], v13 offset:4608
    s_waitcnt lgkmcnt(8)
    v_mfma_f32_16x16x32_bf16 v[136:139], v[24:27], v[88:91], v[136:139]
    v_mfma_f32_16x16x32_bf16 v[140:143], v[24:27], v[92:95], v[140:143]
    v_mfma_f32_16x16x32_bf16 v[144:147], v[24:27], v[96:99], v[144:147]
    ds_read_b64_tr_b16 v[20:21], v14 offset:4096
    ds_read_b64_tr_b16 v[22:23], v14 offset:4608
    s_waitcnt lgkmcnt(8)
    v_mfma_f32_16x16x32_bf16 v[148:151], v[28:31], v[88:91], v[148:151]
    v_mfma_f32_16x16x32_bf16 v[152:155], v[28:31], v[92:95], v[152:155]
    v_mfma_f32_16x16x32_bf16 v[156:159], v[28:31], v[96:99], v[156:159]
    ds_read_b64_tr_b16 v[24:25], v11 offset:8192
    ds_read_b64_tr_b16 v[26:27], v11 offset:8704
    s_waitcnt lgkmcnt(8)
    v_mfma_f32_16x16x32_bf16 v[160:163], v[32:35], v[88:91], v[160:163]
    v_mfma_f32_16x16x32_bf16 v[164:167], v[32:35], v[92:95], v[164:167]
    v_mfma_f32_16x16x32_bf16 v[168:171], v[32:35], v[96:99], v[168:171]
    s_add_u32 m0, s36, 0
    s_nop 0
    buffer_load_dwordx4 v9, s[92:95], s96 offen lds
    ds_read_b64_tr_b16 v[28:29], v12 offset:8192
    ds_read_b64_tr_b16 v[30:31], v12 offset:8704
    s_waitcnt lgkmcnt(8)
    v_mfma_f32_16x16x32_bf16 v[172:175], v[36:39], v[88:91], v[172:175]
    v_mfma_f32_16x16x32_bf16 v[176:179], v[36:39], v[92:95], v[176:179]
    v_mfma_f32_16x16x32_bf16 v[180:183], v[36:39], v[96:99], v[180:183]
    ds_read_b64_tr_b16 v[32:33], v13 offset:8192
    ds_read_b64_tr_b16 v[34:35], v13 offset:8704
    s_waitcnt lgkmcnt(8)
    v_mfma_f32_16x16x32_bf16 v[184:187], v[16:19], v[88:91], v[184:187]
    v_mfma_f32_16x16x32_bf16 v[188:191], v[16:19], v[92:95], v[188:191]
    v_mfma_f32_16x16x32_bf16 v[192:195], v[16:19], v[96:99], v[192:195]
    s_add_u32 m0, s36, 3968
    s_nop 0
    buffer_load_dwordx4 v9, s[92:95], s96 offen offset:128 lds
    ds_read_b64_tr_b16 v[36:37], v14 offset:8192
    ds_read_b64_tr_b16 v[38:39], v14 offset:8704
    s_waitcnt lgkmcnt(8)
    v_mfma_f32_16x16x32_bf16 v[196:199], v[20:23], v[88:91], v[196:199]
    v_mfma_f32_16x16x32_bf16 v[200:203], v[20:23], v[92:95], v[200:203]
    v_mfma_f32_16x16x32_bf16 v[204:207], v[20:23], v[96:99], v[204:207]
    s_waitcnt lgkmcnt(6)
    v_mfma_f32_16x16x32_bf16 v[208:211], v[24:27], v[88:91], v[208:211]
    v_mfma_f32_16x16x32_bf16 v[212:215], v[24:27], v[92:95], v[212:215]
    v_mfma_f32_16x16x32_bf16 v[216:219], v[24:27], v[96:99], v[216:219]
    s_add_u32 m0, s36, 7936
    s_nop 0
    buffer_load_dwordx4 v9, s[92:95], s96 offen offset:256 lds
    s_waitcnt lgkmcnt(4)
    v_mfma_f32_16x16x32_bf16 v[220:223], v[28:31], v[88:91], v[220:223]
    v_mfma_f32_16x16x32_bf16 v[224:227], v[28:31], v[92:95], v[224:227]
    v_mfma_f32_16x16x32_bf16 v[228:231], v[28:31], v[96:99], v[228:231]
    s_waitcnt lgkmcnt(2)
    v_mfma_f32_16x16x32_bf16 v[232:235], v[32:35], v[88:91], v[232:235]
    v_mfma_f32_16x16x32_bf16 v[236:239], v[32:35], v[92:95], v[236:239]
    v_mfma_f32_16x16x32_bf16 v[240:243], v[32:35], v[96:99], v[240:243]
    s_waitcnt lgkmcnt(0)
    v_mfma_f32_16x16x32_bf16 v[244:247], v[36:39], v[88:91], v[244:247]
    v_mfma_f32_16x16x32_bf16 v[248:251], v[36:39], v[92:95], v[248:251]
    v_mfma_f32_16x16x32_bf16 v[252:255], v[36:39], v[96:99], v[252:255]
    s_add_u32 s36, s35, s25
    s_add_u32 s35, s35, 12288
    s_cmp_eq_u32 s35, 73728
    s_cselect_b32 s35, 0, s35
    s_add_u32 s37, s37, 1
    s_cmp_lt_u32 s37, 5
    s_cbranch_scc1 attn_kernel_h_qloop
    v_lshlrev_b32 v4, 4, v6
    v_add_u32 v4, 73728, v4
    v_cvt_pk_bf16_f32 v64, v112, v113
    v_cvt_pk_bf16_f32 v65, v114, v115
    v_cvt_pk_bf16_f32 v66, v124, v125
    v_cvt_pk_bf16_f32 v67, v126, v127
    s_nop 0
    v_permlane32_swap_b32 v64, v66
    v_permlane32_swap_b32 v65, v67
    s_nop 0
    v_permlane16_swap_b32 v64, v66
    v_permlane16_swap_b32 v65, v67
    v_cvt_pk_bf16_f32 v68, v136, v137
    v_cvt_pk_bf16_f32 v69, v138, v139
    v_cvt_pk_bf16_f32 v70, v148, v149
    v_cvt_pk_bf16_f32 v71, v150, v151
    s_nop 0
    v_permlane32_swap_b32 v68, v70
    v_permlane32_swap_b32 v69, v71
    s_nop 0
    v_permlane16_swap_b32 v68, v70
    v_permlane16_swap_b32 v69, v71
    v_cvt_pk_bf16_f32 v72, v160, v161
    v_cvt_pk_bf16_f32 v73, v162, v163
    v_cvt_pk_bf16_f32 v74, v172, v173
    v_cvt_pk_bf16_f32 v75, v174, v175
    s_nop 0
    v_permlane32_swap_b32 v72, v74
    v_permlane32_swap_b32 v73, v75
    s_nop 0
    v_permlane16_swap_b32 v72, v74
    v_permlane16_swap_b32 v73, v75
    v_cvt_pk_bf16_f32 v76, v184, v185
    v_cvt_pk_bf16_f32 v77, v186, v187
    v_cvt_pk_bf16_f32 v78, v196, v197
    v_cvt_pk_bf16_f32 v79, v198, v199
    s_nop 0
    v_permlane32_swap_b32 v76, v78
    v_permlane32_swap_b32 v77, v79
    s_nop 0
    v_permlane16_swap_b32 v76, v78
    v_permlane16_swap_b32 v77, v79
    v_cvt_pk_bf16_f32 v80, v208, v209
    v_cvt_pk_bf16_f32 v81, v210, v211
    v_cvt_pk_bf16_f32 v82, v220, v221
    v_cvt_pk_bf16_f32 v83, v222, v223
    s_nop 0
    v_permlane32_swap_b32 v80, v82
    v_permlane32_swap_b32 v81, v83
    s_nop 0
    v_permlane16_swap_b32 v80, v82
    v_permlane16_swap_b32 v81, v83
    v_cvt_pk_bf16_f32 v84, v232, v233
    v_cvt_pk_bf16_f32 v85, v234, v235
    v_cvt_pk_bf16_f32 v86, v244, v245
    v_cvt_pk_bf16_f32 v87, v246, v247
    s_nop 0
    v_permlane32_swap_b32 v84, v86
    v_permlane32_swap_b32 v85, v87
    s_nop 0
    v_permlane16_swap_b32 v84, v86
    v_permlane16_swap_b32 v85, v87
    v_cvt_pk_bf16_f32 v88, v116, v117
    v_cvt_pk_bf16_f32 v89, v118, v119
    v_cvt_pk_bf16_f32 v90, v128, v129
    v_cvt_pk_bf16_f32 v91, v130, v131
    s_nop 0
    v_permlane32_swap_b32 v88, v90
    v_permlane32_swap_b32 v89, v91
    s_nop 0
    v_permlane16_swap_b32 v88, v90
    v_permlane16_swap_b32 v89, v91
    v_cvt_pk_bf16_f32 v92, v140, v141
    v_cvt_pk_bf16_f32 v93, v142, v143
    v_cvt_pk_bf16_f32 v94, v152, v153
    v_cvt_pk_bf16_f32 v95, v154, v155
    s_nop 0
    v_permlane32_swap_b32 v92, v94
    v_permlane32_swap_b32 v93, v95
    s_nop 0
    v_permlane16_swap_b32 v92, v94
    v_permlane16_swap_b32 v93, v95
    v_cvt_pk_bf16_f32 v96, v164, v165
    v_cvt_pk_bf16_f32 v97, v166, v167
    v_cvt_pk_bf16_f32 v98, v176, v177
    v_cvt_pk_bf16_f32 v99, v178, v179
    s_nop 0
    v_permlane32_swap_b32 v96, v98
    v_permlane32_swap_b32 v97, v99
    s_nop 0
    v_permlane16_swap_b32 v96, v98
    v_permlane16_swap_b32 v97, v99
    v_cvt_pk_bf16_f32 v100, v188, v189
    v_cvt_pk_bf16_f32 v101, v190, v191
    v_cvt_pk_bf16_f32 v102, v200, v201
    v_cvt_pk_bf16_f32 v103, v202, v203
    s_nop 0
    v_permlane32_swap_b32 v100, v102
    v_permlane32_swap_b32 v101, v103
    s_nop 0
    v_permlane16_swap_b32 v100, v102
    v_permlane16_swap_b32 v101, v103
    v_cvt_pk_bf16_f32 v104, v212, v213
    v_cvt_pk_bf16_f32 v105, v214, v215
    v_cvt_pk_bf16_f32 v106, v224, v225
    v_cvt_pk_bf16_f32 v107, v226, v227
    s_nop 0
    v_permlane32_swap_b32 v104, v106
    v_permlane32_swap_b32 v105, v107
    s_nop 0
    v_permlane16_swap_b32 v104, v106
    v_permlane16_swap_b32 v105, v107
    v_cvt_pk_bf16_f32 v108, v236, v237
    v_cvt_pk_bf16_f32 v109, v238, v239
    v_cvt_pk_bf16_f32 v110, v248, v249
    v_cvt_pk_bf16_f32 v111, v250, v251
    s_nop 0
    v_permlane32_swap_b32 v108, v110
    v_permlane32_swap_b32 v109, v111
    s_nop 0
    v_permlane16_swap_b32 v108, v110
    v_permlane16_swap_b32 v109, v111
    v_cvt_pk_bf16_f32 v16, v120, v121
    v_cvt_pk_bf16_f32 v17, v122, v123
    v_cvt_pk_bf16_f32 v18, v132, v133
    v_cvt_pk_bf16_f32 v19, v134, v135
    s_nop 0
    v_permlane32_swap_b32 v16, v18
    v_permlane32_swap_b32 v17, v19
    s_nop 0
    v_permlane16_swap_b32 v16, v18
    v_permlane16_swap_b32 v17, v19
    ds_write_b128 v4, v[16:19]
    v_cvt_pk_bf16_f32 v20, v144, v145
    v_cvt_pk_bf16_f32 v21, v146, v147
    v_cvt_pk_bf16_f32 v22, v156, v157
    v_cvt_pk_bf16_f32 v23, v158, v159
    s_nop 0
    v_permlane32_swap_b32 v20, v22
    v_permlane32_swap_b32 v21, v23
    s_nop 0
    v_permlane16_swap_b32 v20, v22
    v_permlane16_swap_b32 v21, v23
    ds_write_b128 v4, v[20:23] offset:1024
    v_cvt_pk_bf16_f32 v24, v168, v169
    v_cvt_pk_bf16_f32 v25, v170, v171
    v_cvt_pk_bf16_f32 v26, v180, v181
    v_cvt_pk_bf16_f32 v27, v182, v183
    s_nop 0
    v_permlane32_swap_b32 v24, v26
    v_permlane32_swap_b32 v25, v27
    s_nop 0
    v_permlane16_swap_b32 v24, v26
    v_permlane16_swap_b32 v25, v27
    ds_write_b128 v4, v[24:27] offset:2048
    v_cvt_pk_bf16_f32 v28, v192, v193
    v_cvt_pk_bf16_f32 v29, v194, v195
    v_cvt_pk_bf16_f32 v30, v204, v205
    v_cvt_pk_bf16_f32 v31, v206, v207
    s_nop 0
    v_permlane32_swap_b32 v28, v30
    v_permlane32_swap_b32 v29, v31
    s_nop 0
    v_permlane16_swap_b32 v28, v30
    v_permlane16_swap_b32 v29, v31
    ds_write_b128 v4, v[28:31] offset:3072
    v_cvt_pk_bf16_f32 v32, v216, v217
    v_cvt_pk_bf16_f32 v33, v218, v219
    v_cvt_pk_bf16_f32 v34, v228, v229
    v_cvt_pk_bf16_f32 v35, v230, v231
    s_nop 0
    v_permlane32_swap_b32 v32, v34
    v_permlane32_swap_b32 v33, v35
    s_nop 0
    v_permlane16_swap_b32 v32, v34
    v_permlane16_swap_b32 v33, v35
    ds_write_b128 v4, v[32:35] offset:4096
    v_cvt_pk_bf16_f32 v36, v240, v241
    v_cvt_pk_bf16_f32 v37, v242, v243
    v_cvt_pk_bf16_f32 v38, v252, v253
    v_cvt_pk_bf16_f32 v39, v254, v255
    s_nop 0
    v_permlane32_swap_b32 v36, v38
    v_permlane32_swap_b32 v37, v39
    s_nop 0
    v_permlane16_swap_b32 v36, v38
    v_permlane16_swap_b32 v37, v39
    ds_write_b128 v4, v[36:39] offset:5120
    v_mov_b32 v112, 0
    v_mov_b32 v113, 0
    v_mov_b32 v114, 0
    v_mov_b32 v115, 0
    v_mov_b32 v116, 0
    v_mov_b32 v117, 0
    v_mov_b32 v118, 0
    v_mov_b32 v119, 0
    v_mov_b32 v120, 0
    v_mov_b32 v121, 0
    v_mov_b32 v122, 0
    v_mov_b32 v123, 0
    v_mov_b32 v124, 0
    v_mov_b32 v125, 0
    v_mov_b32 v126, 0
    v_mov_b32 v127, 0
    v_mov_b32 v128, 0
    v_mov_b32 v129, 0
    v_mov_b32 v130, 0
    v_mov_b32 v131, 0
    v_mov_b32 v132, 0
    v_mov_b32 v133, 0
    v_mov_b32 v134, 0
    v_mov_b32 v135, 0
    v_mov_b32 v136, 0
    v_mov_b32 v137, 0
    v_mov_b32 v138, 0
    v_mov_b32 v139, 0
    v_mov_b32 v140, 0
    v_mov_b32 v141, 0
    v_mov_b32 v142, 0
    v_mov_b32 v143, 0
    v_mov_b32 v144, 0
    v_mov_b32 v145, 0
    v_mov_b32 v146, 0
    v_mov_b32 v147, 0
    v_mov_b32 v148, 0
    v_mov_b32 v149, 0
    v_mov_b32 v150, 0
    v_mov_b32 v151, 0
    v_mov_b32 v152, 0
    v_mov_b32 v153, 0
    v_mov_b32 v154, 0
    v_mov_b32 v155, 0
    v_mov_b32 v156, 0
    v_mov_b32 v157, 0
    v_mov_b32 v158, 0
    v_mov_b32 v159, 0
    v_mov_b32 v160, 0
    v_mov_b32 v161, 0
    v_mov_b32 v162, 0
    v_mov_b32 v163, 0
    v_mov_b32 v164, 0
    v_mov_b32 v165, 0
    v_mov_b32 v166, 0
    v_mov_b32 v167, 0
    v_mov_b32 v168, 0
    v_mov_b32 v169, 0
    v_mov_b32 v170, 0
    v_mov_b32 v171, 0
    v_mov_b32 v172, 0
    v_mov_b32 v173, 0
    v_mov_b32 v174, 0
    v_mov_b32 v175, 0
    v_mov_b32 v176, 0
    v_mov_b32 v177, 0
    v_mov_b32 v178, 0
    v_mov_b32 v179, 0
    v_mov_b32 v180, 0
    v_mov_b32 v181, 0
    v_mov_b32 v182, 0
    v_mov_b32 v183, 0
    v_mov_b32 v184, 0
    v_mov_b32 v185, 0
    v_mov_b32 v186, 0
    v_mov_b32 v187, 0
    v_mov_b32 v188, 0
    v_mov_b32 v189, 0
    v_mov_b32 v190, 0
    v_mov_b32 v191, 0
    v_mov_b32 v192, 0
    v_mov_b32 v193, 0
    v_mov_b32 v194, 0
    v_mov_b32 v195, 0
    v_mov_b32 v196, 0
    v_mov_b32 v197, 0
    v_mov_b32 v198, 0
    v_mov_b32 v199, 0
    v_mov_b32 v200, 0
    v_mov_b32 v201, 0
    v_mov_b32 v202, 0
    v_mov_b32 v203, 0
    v_mov_b32 v204, 0
    v_mov_b32 v205, 0
    v_mov_b32 v206, 0
    v_mov_b32 v207, 0
    v_mov_b32 v208, 0
    v_mov_b32 v209, 0
    v_mov_b32 v210, 0
    v_mov_b32 v211, 0
    v_mov_b32 v212, 0
    v_mov_b32 v213, 0
    v_mov_b32 v214, 0
    v_mov_b32 v215, 0
    v_mov_b32 v216, 0
    v_mov_b32 v217, 0
    v_mov_b32 v218, 0
    v_mov_b32 v219, 0
    v_mov_b32 v220, 0
    v_mov_b32 v221, 0
    v_mov_b32 v222, 0
    v_mov_b32 v223, 0
    v_mov_b32 v224, 0
    v_mov_b32 v225, 0
    v_mov_b32 v226, 0
    v_mov_b32 v227, 0
    v_mov_b32 v228, 0
    v_mov_b32 v229, 0
    v_mov_b32 v230, 0
    v_mov_b32 v231, 0
    v_mov_b32 v232, 0
    v_mov_b32 v233, 0
    v_mov_b32 v234, 0
    v_mov_b32 v235, 0
    v_mov_b32 v236, 0
    v_mov_b32 v237, 0
    v_mov_b32 v238, 0
    v_mov_b32 v239, 0
    v_mov_b32 v240, 0
    v_mov_b32 v241, 0
    v_mov_b32 v242, 0
    v_mov_b32 v243, 0
    v_mov_b32 v244, 0
    v_mov_b32 v245, 0
    v_mov_b32 v246, 0
    v_mov_b32 v247, 0
    v_mov_b32 v248, 0
    v_mov_b32 v249, 0
    v_mov_b32 v250, 0
    v_mov_b32 v251, 0
    v_mov_b32 v252, 0
    v_mov_b32 v253, 0
    v_mov_b32 v254, 0
    v_mov_b32 v255, 0
    v_mov_b32 v5, 4048155338
    v_mov_b32 v8, 0
    v_mov_b32 v6, 4048155338
    v_mov_b32 v9, 0
    v_mov_b32 v7, 4048155338
    v_mov_b32 v10, 0
    s_waitcnt lgkmcnt(0)
    s_mov_b32 s37, 0
    s_nop 3
attn_kernel_h_loop:
    s_waitcnt vmcnt(12)
    s_barrier
    s_cmp_lt_u32 s32, s33
    s_cselect_b32 s41, s32, s34
    s_add_u32 s32, s32, 12288
    v_add_u32 v11, s35, v0
    v_xor_b32 v12, 64, v11
    ds_read_b128 v[16:19], v11
    ds_read_b128 v[20:23], v11 offset:2048
    ds_read_b128 v[24:27], v4
    ds_read_b128 v[28:31], v12
    ds_read_b128 v[32:35], v12 offset:2048
    ds_read_b128 v[36:39], v4 offset:1024
    s_waitcnt lgkmcnt(3)
    v_mfma_f32_16x16x32_bf16 v[40:43], v[16:19], v[64:67], 0
    v_mfma_f32_16x16x32_bf16 v[44:47], v[16:19], v[88:91], 0
    v_mfma_f32_16x16x32_bf16 v[48:51], v[16:19], v[24:27], 0
    v_mfma_f32_16x16x32_bf16 v[52:55], v[20:23], v[64:67], 0
    v_mfma_f32_16x16x32_bf16 v[56:59], v[20:23], v[88:91], 0
    v_mfma_f32_16x16x32_bf16 v[60:63], v[20:23], v[24:27], 0
    ds_read_b128 v[16:19], v11 offset:4096
    ds_read_b128 v[20:23], v11 offset:6144
    ds_read_b128 v[24:27], v4 offset:2048
    s_add_u32 m0, s36, 0
    s_nop 0
    buffer_load_dwordx4 v3, s[12:15], s41 offen nt lds
    s_waitcnt lgkmcnt(3)
    v_mfma_f32_16x16x32_bf16 v[40:43], v[28:31], v[68:71], v[40:43]
    v_mfma_f32_16x16x32_bf16 v[44:47], v[28:31], v[92:95], v[44:47]
    v_mfma_f32_16x16x32_bf16 v[48:51], v[28:31], v[36:39], v[48:51]
    v_mfma_f32_16x16x32_bf16 v[52:55], v[32:35], v[68:71], v[52:55]
    v_mfma_f32_16x16x32_bf16 v[56:59], v[32:35], v[92:95], v[56:59]
    v_mfma_f32_16x16x32_bf16 v[60:63], v[32:35], v[36:39], v[60:63]
    ds_read_b128 v[28:31], v12 offset:4096
    ds_read_b128 v[32:35], v12 offset:6144
    ds_read_b128 v[36:39], v4 offset:3072
    s_waitcnt lgkmcnt(3)
    v_mfma_f32_16x16x32_bf16 v[40:43], v[16:19], v[72:75], v[40:43]
    v_mfma_f32_16x16x32_bf16 v[44:47], v[16:19], v[96:99], v[44:47]
    v_mfma_f32_16x16x32_bf16 v[48:51], v[16:19], v[24:27], v[48:51]
    v_mfma_f32_16x16x32_bf16 v[52:55], v[20:23], v[72:75], v[52:55]
    v_mfma_f32_16x16x32_bf16 v[56:59], v[20:23], v[96:99], v[56:59]
    v_mfma_f32_16x16x32_bf16 v[60:63], v[20:23], v[24:27], v[60:63]
    ds_read_b128 v[16:19], v11 offset:8192
    ds_read_b128 v[20:23], v11 offset:10240
    ds_read_b128 v[24:27], v4 offset:4096
    s_add_u32 m0, s36, 3968
    s_nop 0
    buffer_load_dwordx4 v3, s[12:15], s41 offen offset:128 nt lds
    s_waitcnt lgkmcnt(3)
    v_mfma_f32_16x16x32_bf16 v[40:43], v[28:31], v[76:79], v[40:43]
    v_mfma_f32_16x16x32_bf16 v[44:47], v[28:31], v[100:103], v[44:47]
    v_mfma_f32_16x16x32_bf16 v[48:51], v[28:31], v[36:39], v[48:51]
    v_mfma_f32_16x16x32_bf16 v[52:55], v[32:35], v[76:79], v[52:55]
    v_mfma_f32_16x16x32_bf16 v[56:59], v[32:35], v[100:103], v[56:59]
    v_mfma_f32_16x16x32_bf16 v[60:63], v[32:35], v[36:39], v[60:63]
    ds_read_b128 v[28:31], v12 offset:8192
    ds_read_b128 v[32:35], v12 offset:10240
    ds_read_b128 v[36:39], v4 offset:5120
    s_waitcnt lgkmcnt(3)
    v_mfma_f32_16x16x32_bf16 v[40:43], v[16:19], v[80:83], v[40:43]
    v_mfma_f32_16x16x32_bf16 v[44:47], v[16:19], v[104:107], v[44:47]
    v_mfma_f32_16x16x32_bf16 v[48:51], v[16:19], v[24:27], v[48:51]
    v_mfma_f32_16x16x32_bf16 v[52:55], v[20:23], v[80:83], v[52:55]
    v_mfma_f32_16x16x32_bf16 v[56:59], v[20:23], v[104:107], v[56:59]
    v_mfma_f32_16x16x32_bf16 v[60:63], v[20:23], v[24:27], v[60:63]
    s_add_u32 m0, s36, 7936
    s_nop 0
    buffer_load_dwordx4 v3, s[12:15], s41 offen offset:256 nt lds
    s_waitcnt lgkmcnt(0)
    v_mfma_f32_16x16x32_bf16 v[40:43], v[28:31], v[84:87], v[40:43]
    v_mfma_f32_16x16x32_bf16 v[44:47], v[28:31], v[108:111], v[44:47]
    v_mfma_f32_16x16x32_bf16 v[48:51], v[28:31], v[36:39], v[48:51]
    v_mfma_f32_16x16x32_bf16 v[52:55], v[32:35], v[84:87], v[52:55]
    v_mfma_f32_16x16x32_bf16 v[56:59], v[32:35], v[108:111], v[56:59]
    v_mfma_f32_16x16x32_bf16 v[60:63], v[32:35], v[36:39], v[60:63]
    s_add_u32 s36, s35, s25
    s_add_u32 s35, s35, 12288
    s_cmp_eq_u32 s35, 73728
    s_cselect_b32 s35, 0, s35
    v_max3_f32 v16, v40, v41, v42
    s_nop 0
    v_max3_f32 v16, v16, v43, v52
    v_max3_f32 v16, v16, v53, v54
    v_max_f32 v16, v16, v55
    v_fma_f32 v19, v16, s38, -v5
    v_max3_f32 v17, v44, v45, v46
    v_max3_f32 v17, v17, v47, v56
    v_max3_f32 v17, v17, v57, v58
    v_max_f32 v17, v17, v59
    v_fma_f32 v20, v17, s38, -v6
    v_max3_f32 v18, v48, v49, v50
    v_max3_f32 v18, v18, v51, v60
    v_max3_f32 v18, v18, v61, v62
    v_max_f32 v18, v18, v63
    v_fma_f32 v21, v18, s38, -v7
    v_max3_f32 v19, v19, v20, v21
    v_cmp_lt_f32 vcc, s39, v19
    s_cbranch_vccnz attn_kernel_h_rare
attn_kernel_h_back:
    v_fma_f32 v40, v40, s38, -v5
    v_fma_f32 v41, v41, s38, -v5
    v_fma_f32 v42, v42, s38, -v5
    v_fma_f32 v43, v43, s38, -v5
    v_fma_f32 v52, v52, s38, -v5
    v_fma_f32 v53, v53, s38, -v5
    v_fma_f32 v54, v54, s38, -v5
    v_fma_f32 v55, v55, s38, -v5
    v_exp_f32 v40, v40
    v_exp_f32 v41, v41
    v_exp_f32 v42, v42
    v_exp_f32 v43, v43
    v_exp_f32 v52, v52
    v_exp_f32 v53, v53
    v_exp_f32 v54, v54
    v_exp_f32 v55, v55
    v_add_f32 v24, v40, v41
    v_add_f32 v25, v42, v43
    v_add_f32 v26, v52, v53
    v_add_f32 v27, v54, v55
    v_add_f32 v24, v24, v25
    v_add_f32 v26, v26, v27
    v_add_f32 v8, v8, v24
    v_add_f32 v8, v8, v26
    v_cvt_pk_bf16_f32 v40, v40, v41
    v_cvt_pk_bf16_f32 v41, v42, v43
    v_cvt_pk_bf16_f32 v42, v52, v53
    v_cvt_pk_bf16_f32 v43, v54, v55
    v_fma_f32 v44, v44, s38, -v6
    v_fma_f32 v45, v45, s38, -v6
    v_fma_f32 v46, v46, s38, -v6
    v_fma_f32 v47, v47, s38, -v6
    v_fma_f32 v56, v56, s38, -v6
    v_fma_f32 v57, v57, s38, -v6
    v_fma_f32 v58, v58, s38, -v6
    v_fma_f32 v59, v59, s38, -v6
    v_exp_f32 v44, v44
    v_exp_f32 v45, v45
    v_exp_f32 v46, v46
    v_exp_f32 v47, v47
    v_exp_f32 v56, v56
    v_exp_f32 v57, v57
    v_exp_f32 v58, v58
    v_exp_f32 v59, v59
    v_add_f32 v24, v44, v45
    v_add_f32 v25, v46, v47
    v_add_f32 v26, v56, v57
    v_add_f32 v27, v58, v59
    v_add_f32 v24, v24, v25
    v_add_f32 v26, v26, v27
    v_add_f32 v9, v9, v24
    v_add_f32 v9, v9, v26
    v_cvt_pk_bf16_f32 v44, v44, v45
    v_cvt_pk_bf16_f32 v45, v46, v47
    v_cvt_pk_bf16_f32 v46, v56, v57
    v_cvt_pk_bf16_f32 v47, v58, v59
    v_fma_f32 v48, v48, s38, -v7
    v_fma_f32 v49, v49, s38, -v7
    v_fma_f32 v50, v50, s38, -v7
    v_fma_f32 v51, v51, s38, -v7
    v_fma_f32 v60, v60, s38, -v7
    v_fma_f32 v61, v61, s38, -v7
    v_fma_f32 v62, v62, s38, -v7
    v_fma_f32 v63, v63, s38, -v7
    v_exp_f32 v48, v48
    v_exp_f32 v49, v49
    v_exp_f32 v50, v50
    v_exp_f32 v51, v51
    v_exp_f32 v60, v60
    v_exp_f32 v61, v61
    v_exp_f32 v62, v62
    v_exp_f32 v63, v63
    v_add_f32 v24, v48, v49
    v_add_f32 v25, v50, v51
    v_add_f32 v26, v60, v61
    v_add_f32 v27, v62, v63
    v_add_f32 v24, v24, v25
    v_add_f32 v26, v26, v27
    v_add_f32 v10, v10, v24
    v_add_f32 v10, v10, v26
    v_cvt_pk_bf16_f32 v48, v48, v49
    v_cvt_pk_bf16_f32 v49, v50, v51
    v_cvt_pk_bf16_f32 v50, v60, v61
    v_cvt_pk_bf16_f32 v51, v62, v63
    s_waitcnt vmcnt(12)
    s_barrier
    s_cmp_lt_u32 s30, s31
    s_cselect_b32 s41, s30, s34
    s_add_u32 s30, s30, 12288
    v_add_u32 v11, s35, v1
    v_xor_b32 v12, 32, v11
    v_xor_b32 v13, 64, v11
    v_xor_b32 v14, 96, v11
    ds_read_b64_tr_b16 v[16:17], v11
    ds_read_b64_tr_b16 v[18:19], v11 offset:2048
    ds_read_b64_tr_b16 v[20:21], v12
    ds_read_b64_tr_b16 v[22:23], v12 offset:2048
    ds_read_b64_tr_b16 v[24:25], v13
    ds_read_b64_tr_b16 v[26:27], v13 offset:2048
    ds_read_b64_tr_b16 v[28:29], v14
    ds_read_b64_tr_b16 v[30:31], v14 offset:2048
    ds_read_b64_tr_b16 v[32:33], v11 offset:4096
    ds_read_b64_tr_b16 v[34:35], v11 offset:6144
    s_waitcnt lgkmcnt(8)
    v_mfma_f32_16x16x32_bf16 v[112:115], v[16:19], v[40:43], v[112:115]
    v_mfma_f32_16x16x32_bf16 v[116:119], v[16:19], v[44:47], v[116:119]
    v_mfma_f32_16x16x32_bf16 v[120:123], v[16:19], v[48:51], v[120:123]
    ds_read_b64_tr_b16 v[36:37], v12 offset:4096
    ds_read_b64_tr_b16 v[38:39], v12 offset:6144
    s_waitcnt lgkmcnt(8)
    v_mfma_f32_16x16x32_bf16 v[124:127], v[20:23], v[40:43], v[124:127]
    v_mfma_f32_16x16x32_bf16 v[128:131], v[20:23], v[44:47], v[128:131]
    v_mfma_f32_16x16x32_bf16 v[132:135], v[20:23], v[48:51], v[132:135]
    s_add_u32 m0, s36, 0
    s_nop 0
    buffer_load_dwordx4 v2, s[8:11], s41 offen nt lds
    ds_read_b64_tr_b16 v[16:17], v13 offset:4096
    ds_read_b64_tr_b16 v[18:19], v13 offset:6144
    s_waitcnt lgkmcnt(8)
    v_mfma_f32_16x16x32_bf16 v[136:139], v[24:27], v[40:43], v[136:139]
    v_mfma_f32_16x16x32_bf16 v[140:143], v[24:27], v[44:47], v[140:143]
    v_mfma_f32_16x16x32_bf16 v[144:147], v[24:27], v[48:51], v[144:147]
    ds_read_b64_tr_b16 v[20:21], v14 offset:4096
    ds_read_b64_tr_b16 v[22:23], v14 offset:6144
    s_waitcnt lgkmcnt(8)
    v_mfma_f32_16x16x32_bf16 v[148:151], v[28:31], v[40:43], v[148:151]
    v_mfma_f32_16x16x32_bf16 v[152:155], v[28:31], v[44:47], v[152:155]
    v_mfma_f32_16x16x32_bf16 v[156:159], v[28:31], v[48:51], v[156:159]
    ds_read_b64_tr_b16 v[24:25], v11 offset:8192
    ds_read_b64_tr_b16 v[26:27], v11 offset:10240
    s_waitcnt lgkmcnt(8)
    v_mfma_f32_16x16x32_bf16 v[160:163], v[32:35], v[40:43], v[160:163]
    v_mfma_f32_16x16x32_bf16 v[164:167], v[32:35], v[44:47], v[164:167]
    v_mfma_f32_16x16x32_bf16 v[168:171], v[32:35], v[48:51], v[168:171]
    s_add_u32 m0, s36, 3968
    s_nop 0
    buffer_load_dwordx4 v2, s[8:11], s41 offen offset:128 nt lds
    ds_read_b64_tr_b16 v[28:29], v12 offset:8192
    ds_read_b64_tr_b16 v[30:31], v12 offset:10240
    s_waitcnt lgkmcnt(8)
    v_mfma_f32_16x16x32_bf16 v[172:175], v[36:39], v[40:43], v[172:175]
    v_mfma_f32_16x16x32_bf16 v[176:179], v[36:39], v[44:47], v[176:179]
    v_mfma_f32_16x16x32_bf16 v[180:183], v[36:39], v[48:51], v[180:183]
    ds_read_b64_tr_b16 v[32:33], v13 offset:8192
    ds_read_b64_tr_b16 v[34:35], v13 offset:10240
    s_waitcnt lgkmcnt(8)
    v_mfma_f32_16x16x32_bf16 v[184:187], v[16:19], v[40:43], v[184:187]
    v_mfma_f32_16x16x32_bf16 v[188:191], v[16:19], v[44:47], v[188:191]
    v_mfma_f32_16x16x32_bf16 v[192:195], v[16:19], v[48:51], v[192:195]
    ds_read_b64_tr_b16 v[36:37], v14 offset:8192
    ds_read_b64_tr_b16 v[38:39], v14 offset:10240
    s_waitcnt lgkmcnt(8)
    v_mfma_f32_16x16x32_bf16 v[196:199], v[20:23], v[40:43], v[196:199]
    v_mfma_f32_16x16x32_bf16 v[200:203], v[20:23], v[44:47], v[200:203]
    v_mfma_f32_16x16x32_bf16 v[204:207], v[20:23], v[48:51], v[204:207]
    s_add_u32 m0, s36, 7936
    s_nop 0
    buffer_load_dwordx4 v2, s[8:11], s41 offen offset:256 nt lds
    s_waitcnt lgkmcnt(6)
    v_mfma_f32_16x16x32_bf16 v[208:211], v[24:27], v[40:43], v[208:211]
    v_mfma_f32_16x16x32_bf16 v[212:215], v[24:27], v[44:47], v[212:215]
    v_mfma_f32_16x16x32_bf16 v[216:219], v[24:27], v[48:51], v[216:219]
    s_waitcnt lgkmcnt(4)
    v_mfma_f32_16x16x32_bf16 v[220:223], v[28:31], v[40:43], v[220:223]
    v_mfma_f32_16x16x32_bf16 v[224:227], v[28:31], v[44:47], v[224:227]
    v_mfma_f32_16x16x32_bf16 v[228:231], v[28:31], v[48:51], v[228:231]
    s_waitcnt lgkmcnt(2)
    v_mfma_f32_16x16x32_bf16 v[232:235], v[32:35], v[40:43], v[232:235]
    v_mfma_f32_16x16x32_bf16 v[236:239], v[32:35], v[44:47], v[236:239]
    v_mfma_f32_16x16x32_bf16 v[240:243], v[32:35], v[48:51], v[240:243]
    s_waitcnt lgkmcnt(0)
    v_mfma_f32_16x16x32_bf16 v[244:247], v[36:39], v[40:43], v[244:247]
    v_mfma_f32_16x16x32_bf16 v[248:251], v[36:39], v[44:47], v[248:251]
    v_mfma_f32_16x16x32_bf16 v[252:255], v[36:39], v[48:51], v[252:255]
    s_add_u32 s36, s35, s25
    s_add_u32 s35, s35, 12288
    s_cmp_eq_u32 s35, 73728
    s_cselect_b32 s35, 0, s35
    s_add_u32 s37, s37, 1
    s_cmp_lt_u32 s37, 16
    s_cbranch_scc1 attn_kernel_h_loop
    v_mbcnt_lo_u32_b32 v12, -1, 0
    v_mbcnt_hi_u32_b32 v12, -1, v12
    v_and_b32 v11, 15, v12
    v_add_u32 v11, s57, v11
    v_lshlrev_b32 v11, 7, v11
    v_lshrrev_b32 v12, 4, v12
    v_lshl_add_u32 v11, v12, 4, v11
    v_add_u32 v12, 4096, v11
    v_mov_b32 v16, v8
    s_nop 1
    v_permlane32_swap_b32 v8, v16
    v_add_f32 v8, v8, v16
    v_mov_b32 v16, v8
    s_nop 1
    v_permlane16_swap_b32 v8, v16
    v_add_f32 v8, v8, v16
    v_rcp_f32 v8, v8
    v_mov_b32 v16, v9
    s_nop 1
    v_permlane32_swap_b32 v9, v16
    v_add_f32 v9, v9, v16
    v_mov_b32 v16, v9
    s_nop 1
    v_permlane16_swap_b32 v9, v16
    v_add_f32 v9, v9, v16
    v_rcp_f32 v9, v9
    v_mov_b32 v16, v10
    s_nop 1
    v_permlane32_swap_b32 v10, v16
    v_add_f32 v10, v10, v16
    v_mov_b32 v16, v10
    s_nop 1
    v_permlane16_swap_b32 v10, v16
    v_add_f32 v10, v10, v16
    v_rcp_f32 v10, v10
    v_mul_f32 v112, v112, v8
    v_mul_f32 v113, v113, v8
    v_mul_f32 v114, v114, v8
    v_mul_f32 v115, v115, v8
    v_mul_f32 v124, v124, v8
    v_mul_f32 v125, v125, v8
    v_mul_f32 v126, v126, v8
    v_mul_f32 v127, v127, v8
    v_cvt_pk_bf16_f32 v16, v112, v113
    v_cvt_pk_bf16_f32 v17, v114, v115
    v_cvt_pk_bf16_f32 v18, v124, v125
    v_cvt_pk_bf16_f32 v19, v126, v127
    s_nop 0
    v_permlane32_swap_b32 v16, v18
    v_permlane32_swap_b32 v17, v19
    s_nop 0
    v_permlane16_swap_b32 v16, v18
    v_permlane16_swap_b32 v17, v19
    buffer_store_dwordx4 v[16:19], v11, s[20:23], s54 offen
    v_mul_f32 v136, v136, v8
    v_mul_f32 v137, v137, v8
    v_mul_f32 v138, v138, v8
    v_mul_f32 v139, v139, v8
    v_mul_f32 v148, v148, v8
    v_mul_f32 v149, v149, v8
    v_mul_f32 v150, v150, v8
    v_mul_f32 v151, v151, v8
    v_cvt_pk_bf16_f32 v20, v136, v137
    v_cvt_pk_bf16_f32 v21, v138, v139
    v_cvt_pk_bf16_f32 v22, v148, v149
    v_cvt_pk_bf16_f32 v23, v150, v151
    s_nop 0
    v_permlane32_swap_b32 v20, v22
    v_permlane32_swap_b32 v21, v23
    s_nop 0
    v_permlane16_swap_b32 v20, v22
    v_permlane16_swap_b32 v21, v23
    buffer_store_dwordx4 v[20:23], v11, s[20:23], s54 offen offset:64
    v_mul_f32 v160, v160, v8
    v_mul_f32 v161, v161, v8
    v_mul_f32 v162, v162, v8
    v_mul_f32 v163, v163, v8
    v_mul_f32 v172, v172, v8
    v_mul_f32 v173, v173, v8
    v_mul_f32 v174, v174, v8
    v_mul_f32 v175, v175, v8
    v_cvt_pk_bf16_f32 v24, v160, v161
    v_cvt_pk_bf16_f32 v25, v162, v163
    v_cvt_pk_bf16_f32 v26, v172, v173
    v_cvt_pk_bf16_f32 v27, v174, v175
    s_nop 0
    v_permlane32_swap_b32 v24, v26
    v_permlane32_swap_b32 v25, v27
    s_nop 0
    v_permlane16_swap_b32 v24, v26
    v_permlane16_swap_b32 v25, v27
    buffer_store_dwordx4 v[24:27], v11, s[20:23], s55 offen
    v_mul_f32 v184, v184, v8
    v_mul_f32 v185, v185, v8
    v_mul_f32 v186, v186, v8
    v_mul_f32 v187, v187, v8
    v_mul_f32 v196, v196, v8
    v_mul_f32 v197, v197, v8
    v_mul_f32 v198, v198, v8
    v_mul_f32 v199, v199, v8
    v_cvt_pk_bf16_f32 v28, v184, v185
    v_cvt_pk_bf16_f32 v29, v186, v187
    v_cvt_pk_bf16_f32 v30, v196, v197
    v_cvt_pk_bf16_f32 v31, v198, v199
    s_nop 0
    v_permlane32_swap_b32 v28, v30
    v_permlane32_swap_b32 v29, v31
    s_nop 0
    v_permlane16_swap_b32 v28, v30
    v_permlane16_swap_b32 v29, v31
    buffer_store_dwordx4 v[28:31], v11, s[20:23], s55 offen offset:64
    v_mul_f32 v208, v208, v8
    v_mul_f32 v209, v209, v8
    v_mul_f32 v210, v210, v8
    v_mul_f32 v211, v211, v8
    v_mul_f32 v220, v220, v8
    v_mul_f32 v221, v221, v8
    v_mul_f32 v222, v222, v8
    v_mul_f32 v223, v223, v8
    v_cvt_pk_bf16_f32 v32, v208, v209
    v_cvt_pk_bf16_f32 v33, v210, v211
    v_cvt_pk_bf16_f32 v34, v220, v221
    v_cvt_pk_bf16_f32 v35, v222, v223
    s_nop 0
    v_permlane32_swap_b32 v32, v34
    v_permlane32_swap_b32 v33, v35
    s_nop 0
    v_permlane16_swap_b32 v32, v34
    v_permlane16_swap_b32 v33, v35
    buffer_store_dwordx4 v[32:35], v11, s[20:23], s56 offen
    v_mul_f32 v232, v232, v8
    v_mul_f32 v233, v233, v8
    v_mul_f32 v234, v234, v8
    v_mul_f32 v235, v235, v8
    v_mul_f32 v244, v244, v8
    v_mul_f32 v245, v245, v8
    v_mul_f32 v246, v246, v8
    v_mul_f32 v247, v247, v8
    v_cvt_pk_bf16_f32 v36, v232, v233
    v_cvt_pk_bf16_f32 v37, v234, v235
    v_cvt_pk_bf16_f32 v38, v244, v245
    v_cvt_pk_bf16_f32 v39, v246, v247
    s_nop 0
    v_permlane32_swap_b32 v36, v38
    v_permlane32_swap_b32 v37, v39
    s_nop 0
    v_permlane16_swap_b32 v36, v38
    v_permlane16_swap_b32 v37, v39
    buffer_store_dwordx4 v[36:39], v11, s[20:23], s56 offen offset:64
    v_mul_f32 v116, v116, v9
    v_mul_f32 v117, v117, v9
    v_mul_f32 v118, v118, v9
    v_mul_f32 v119, v119, v9
    v_mul_f32 v128, v128, v9
    v_mul_f32 v129, v129, v9
    v_mul_f32 v130, v130, v9
    v_mul_f32 v131, v131, v9
    v_cvt_pk_bf16_f32 v16, v116, v117
    v_cvt_pk_bf16_f32 v17, v118, v119
    v_cvt_pk_bf16_f32 v18, v128, v129
    v_cvt_pk_bf16_f32 v19, v130, v131
    s_nop 0
    v_permlane32_swap_b32 v16, v18
    v_permlane32_swap_b32 v17, v19
    s_nop 0
    v_permlane16_swap_b32 v16, v18
    v_permlane16_swap_b32 v17, v19
    buffer_store_dwordx4 v[16:19], v11, s[20:23], s54 offen offset:2048
    v_mul_f32 v140, v140, v9
    v_mul_f32 v141, v141, v9
    v_mul_f32 v142, v142, v9
    v_mul_f32 v143, v143, v9
    v_mul_f32 v152, v152, v9
    v_mul_f32 v153, v153, v9
    v_mul_f32 v154, v154, v9
    v_mul_f32 v155, v155, v9
    v_cvt_pk_bf16_f32 v20, v140, v141
    v_cvt_pk_bf16_f32 v21, v142, v143
    v_cvt_pk_bf16_f32 v22, v152, v153
    v_cvt_pk_bf16_f32 v23, v154, v155
    s_nop 0
    v_permlane32_swap_b32 v20, v22
    v_permlane32_swap_b32 v21, v23
    s_nop 0
    v_permlane16_swap_b32 v20, v22
    v_permlane16_swap_b32 v21, v23
    buffer_store_dwordx4 v[20:23], v11, s[20:23], s54 offen offset:2112
    v_mul_f32 v164, v164, v9
    v_mul_f32 v165, v165, v9
    v_mul_f32 v166, v166, v9
    v_mul_f32 v167, v167, v9
    v_mul_f32 v176, v176, v9
    v_mul_f32 v177, v177, v9
    v_mul_f32 v178, v178, v9
    v_mul_f32 v179, v179, v9
    v_cvt_pk_bf16_f32 v24, v164, v165
    v_cvt_pk_bf16_f32 v25, v166, v167
    v_cvt_pk_bf16_f32 v26, v176, v177
    v_cvt_pk_bf16_f32 v27, v178, v179
    s_nop 0
    v_permlane32_swap_b32 v24, v26
    v_permlane32_swap_b32 v25, v27
    s_nop 0
    v_permlane16_swap_b32 v24, v26
    v_permlane16_swap_b32 v25, v27
    buffer_store_dwordx4 v[24:27], v11, s[20:23], s55 offen offset:2048
    v_mul_f32 v188, v188, v9
    v_mul_f32 v189, v189, v9
    v_mul_f32 v190, v190, v9
    v_mul_f32 v191, v191, v9
    v_mul_f32 v200, v200, v9
    v_mul_f32 v201, v201, v9
    v_mul_f32 v202, v202, v9
    v_mul_f32 v203, v203, v9
    v_cvt_pk_bf16_f32 v28, v188, v189
    v_cvt_pk_bf16_f32 v29, v190, v191
    v_cvt_pk_bf16_f32 v30, v200, v201
    v_cvt_pk_bf16_f32 v31, v202, v203
    s_nop 0
    v_permlane32_swap_b32 v28, v30
    v_permlane32_swap_b32 v29, v31
    s_nop 0
    v_permlane16_swap_b32 v28, v30
    v_permlane16_swap_b32 v29, v31
    buffer_store_dwordx4 v[28:31], v11, s[20:23], s55 offen offset:2112
    v_mul_f32 v212, v212, v9
    v_mul_f32 v213, v213, v9
    v_mul_f32 v214, v214, v9
    v_mul_f32 v215, v215, v9
    v_mul_f32 v224, v224, v9
    v_mul_f32 v225, v225, v9
    v_mul_f32 v226, v226, v9
    v_mul_f32 v227, v227, v9
    v_cvt_pk_bf16_f32 v32, v212, v213
    v_cvt_pk_bf16_f32 v33, v214, v215
    v_cvt_pk_bf16_f32 v34, v224, v225
    v_cvt_pk_bf16_f32 v35, v226, v227
    s_nop 0
    v_permlane32_swap_b32 v32, v34
    v_permlane32_swap_b32 v33, v35
    s_nop 0
    v_permlane16_swap_b32 v32, v34
    v_permlane16_swap_b32 v33, v35
    buffer_store_dwordx4 v[32:35], v11, s[20:23], s56 offen offset:2048
    v_mul_f32 v236, v236, v9
    v_mul_f32 v237, v237, v9
    v_mul_f32 v238, v238, v9
    v_mul_f32 v239, v239, v9
    v_mul_f32 v248, v248, v9
    v_mul_f32 v249, v249, v9
    v_mul_f32 v250, v250, v9
    v_mul_f32 v251, v251, v9
    v_cvt_pk_bf16_f32 v36, v236, v237
    v_cvt_pk_bf16_f32 v37, v238, v239
    v_cvt_pk_bf16_f32 v38, v248, v249
    v_cvt_pk_bf16_f32 v39, v250, v251
    s_nop 0
    v_permlane32_swap_b32 v36, v38
    v_permlane32_swap_b32 v37, v39
    s_nop 0
    v_permlane16_swap_b32 v36, v38
    v_permlane16_swap_b32 v37, v39
    buffer_store_dwordx4 v[36:39], v11, s[20:23], s56 offen offset:2112
    v_mul_f32 v120, v120, v10
    v_mul_f32 v121, v121, v10
    v_mul_f32 v122, v122, v10
    v_mul_f32 v123, v123, v10
    v_mul_f32 v132, v132, v10
    v_mul_f32 v133, v133, v10
    v_mul_f32 v134, v134, v10
    v_mul_f32 v135, v135, v10
    v_cvt_pk_bf16_f32 v16, v120, v121
    v_cvt_pk_bf16_f32 v17, v122, v123
    v_cvt_pk_bf16_f32 v18, v132, v133
    v_cvt_pk_bf16_f32 v19, v134, v135
    s_nop 0
    v_permlane32_swap_b32 v16, v18
    v_permlane32_swap_b32 v17, v19
    s_nop 0
    v_permlane16_swap_b32 v16, v18
    v_permlane16_swap_b32 v17, v19
    buffer_store_dwordx4 v[16:19], v12, s[20:23], s54 offen
    v_mul_f32 v144, v144, v10
    v_mul_f32 v145, v145, v10
    v_mul_f32 v146, v146, v10
    v_mul_f32 v147, v147, v10
    v_mul_f32 v156, v156, v10
    v_mul_f32 v157, v157, v10
    v_mul_f32 v158, v158, v10
    v_mul_f32 v159, v159, v10
    v_cvt_pk_bf16_f32 v20, v144, v145
    v_cvt_pk_bf16_f32 v21, v146, v147
    v_cvt_pk_bf16_f32 v22, v156, v157
    v_cvt_pk_bf16_f32 v23, v158, v159
    s_nop 0
    v_permlane32_swap_b32 v20, v22
    v_permlane32_swap_b32 v21, v23
    s_nop 0
    v_permlane16_swap_b32 v20, v22
    v_permlane16_swap_b32 v21, v23
    buffer_store_dwordx4 v[20:23], v12, s[20:23], s54 offen offset:64
    v_mul_f32 v168, v168, v10
    v_mul_f32 v169, v169, v10
    v_mul_f32 v170, v170, v10
    v_mul_f32 v171, v171, v10
    v_mul_f32 v180, v180, v10
    v_mul_f32 v181, v181, v10
    v_mul_f32 v182, v182, v10
    v_mul_f32 v183, v183, v10
    v_cvt_pk_bf16_f32 v24, v168, v169
    v_cvt_pk_bf16_f32 v25, v170, v171
    v_cvt_pk_bf16_f32 v26, v180, v181
    v_cvt_pk_bf16_f32 v27, v182, v183
    s_nop 0
    v_permlane32_swap_b32 v24, v26
    v_permlane32_swap_b32 v25, v27
    s_nop 0
    v_permlane16_swap_b32 v24, v26
    v_permlane16_swap_b32 v25, v27
    buffer_store_dwordx4 v[24:27], v12, s[20:23], s55 offen
    v_mul_f32 v192, v192, v10
    v_mul_f32 v193, v193, v10
    v_mul_f32 v194, v194, v10
    v_mul_f32 v195, v195, v10
    v_mul_f32 v204, v204, v10
    v_mul_f32 v205, v205, v10
    v_mul_f32 v206, v206, v10
    v_mul_f32 v207, v207, v10
    v_cvt_pk_bf16_f32 v28, v192, v193
    v_cvt_pk_bf16_f32 v29, v194, v195
    v_cvt_pk_bf16_f32 v30, v204, v205
    v_cvt_pk_bf16_f32 v31, v206, v207
    s_nop 0
    v_permlane32_swap_b32 v28, v30
    v_permlane32_swap_b32 v29, v31
    s_nop 0
    v_permlane16_swap_b32 v28, v30
    v_permlane16_swap_b32 v29, v31
    buffer_store_dwordx4 v[28:31], v12, s[20:23], s55 offen offset:64
    v_mul_f32 v216, v216, v10
    v_mul_f32 v217, v217, v10
    v_mul_f32 v218, v218, v10
    v_mul_f32 v219, v219, v10
    v_mul_f32 v228, v228, v10
    v_mul_f32 v229, v229, v10
    v_mul_f32 v230, v230, v10
    v_mul_f32 v231, v231, v10
    v_cvt_pk_bf16_f32 v32, v216, v217
    v_cvt_pk_bf16_f32 v33, v218, v219
    v_cvt_pk_bf16_f32 v34, v228, v229
    v_cvt_pk_bf16_f32 v35, v230, v231
    s_nop 0
    v_permlane32_swap_b32 v32, v34
    v_permlane32_swap_b32 v33, v35
    s_nop 0
    v_permlane16_swap_b32 v32, v34
    v_permlane16_swap_b32 v33, v35
    buffer_store_dwordx4 v[32:35], v12, s[20:23], s56 offen
    v_mul_f32 v240, v240, v10
    v_mul_f32 v241, v241, v10
    v_mul_f32 v242, v242, v10
    v_mul_f32 v243, v243, v10
    v_mul_f32 v252, v252, v10
    v_mul_f32 v253, v253, v10
    v_mul_f32 v254, v254, v10
    v_mul_f32 v255, v255, v10
    v_cvt_pk_bf16_f32 v36, v240, v241
    v_cvt_pk_bf16_f32 v37, v242, v243
    v_cvt_pk_bf16_f32 v38, v252, v253
    v_cvt_pk_bf16_f32 v39, v254, v255
    s_nop 0
    v_permlane32_swap_b32 v36, v38
    v_permlane32_swap_b32 v37, v39
    s_nop 0
    v_permlane16_swap_b32 v36, v38
    v_permlane16_swap_b32 v37, v39
    buffer_store_dwordx4 v[36:39], v12, s[20:23], s56 offen offset:64
    s_endpgm
attn_kernel_h_rare:
    s_nop 1
    v_mov_b32 v24, v16
    s_nop 1
    v_permlane32_swap_b32 v16, v24
    v_max_f32 v16, v16, v24
    v_mov_b32 v24, v16
    s_nop 1
    v_permlane16_swap_b32 v16, v24
    v_max_f32 v16, v16, v24
    v_mul_f32 v16, s38, v16
    v_max_f32 v16, v16, v5
    v_sub_f32 v24, v5, v16
    v_exp_f32 v24, v24
    v_mov_b32 v5, v16
    v_mul_f32 v8, v8, v24
    v_mul_f32 v112, v112, v24
    v_mul_f32 v113, v113, v24
    v_mul_f32 v114, v114, v24
    v_mul_f32 v115, v115, v24
    v_mul_f32 v124, v124, v24
    v_mul_f32 v125, v125, v24
    v_mul_f32 v126, v126, v24
    v_mul_f32 v127, v127, v24
    v_mul_f32 v136, v136, v24
    v_mul_f32 v137, v137, v24
    v_mul_f32 v138, v138, v24
    v_mul_f32 v139, v139, v24
    v_mul_f32 v148, v148, v24
    v_mul_f32 v149, v149, v24
    v_mul_f32 v150, v150, v24
    v_mul_f32 v151, v151, v24
    v_mul_f32 v160, v160, v24
    v_mul_f32 v161, v161, v24
    v_mul_f32 v162, v162, v24
    v_mul_f32 v163, v163, v24
    v_mul_f32 v172, v172, v24
    v_mul_f32 v173, v173, v24
    v_mul_f32 v174, v174, v24
    v_mul_f32 v175, v175, v24
    v_mul_f32 v184, v184, v24
    v_mul_f32 v185, v185, v24
    v_mul_f32 v186, v186, v24
    v_mul_f32 v187, v187, v24
    v_mul_f32 v196, v196, v24
    v_mul_f32 v197, v197, v24
    v_mul_f32 v198, v198, v24
    v_mul_f32 v199, v199, v24
    v_mul_f32 v208, v208, v24
    v_mul_f32 v209, v209, v24
    v_mul_f32 v210, v210, v24
    v_mul_f32 v211, v211, v24
    v_mul_f32 v220, v220, v24
    v_mul_f32 v221, v221, v24
    v_mul_f32 v222, v222, v24
    v_mul_f32 v223, v223, v24
    v_mul_f32 v232, v232, v24
    v_mul_f32 v233, v233, v24
    v_mul_f32 v234, v234, v24
    v_mul_f32 v235, v235, v24
    v_mul_f32 v244, v244, v24
    v_mul_f32 v245, v245, v24
    v_mul_f32 v246, v246, v24
    v_mul_f32 v247, v247, v24
    v_mov_b32 v24, v17
    s_nop 1
    v_permlane32_swap_b32 v17, v24
    v_max_f32 v17, v17, v24
    v_mov_b32 v24, v17
    s_nop 1
    v_permlane16_swap_b32 v17, v24
    v_max_f32 v17, v17, v24
    v_mul_f32 v17, s38, v17
    v_max_f32 v17, v17, v6
    v_sub_f32 v24, v6, v17
    v_exp_f32 v24, v24
    v_mov_b32 v6, v17
    v_mul_f32 v9, v9, v24
    v_mul_f32 v116, v116, v24
    v_mul_f32 v117, v117, v24
    v_mul_f32 v118, v118, v24
    v_mul_f32 v119, v119, v24
    v_mul_f32 v128, v128, v24
    v_mul_f32 v129, v129, v24
    v_mul_f32 v130, v130, v24
    v_mul_f32 v131, v131, v24
    v_mul_f32 v140, v140, v24
    v_mul_f32 v141, v141, v24
    v_mul_f32 v142, v142, v24
    v_mul_f32 v143, v143, v24
    v_mul_f32 v152, v152, v24
    v_mul_f32 v153, v153, v24
    v_mul_f32 v154, v154, v24
    v_mul_f32 v155, v155, v24
    v_mul_f32 v164, v164, v24
    v_mul_f32 v165, v165, v24
    v_mul_f32 v166, v166, v24
    v_mul_f32 v167, v167, v24
    v_mul_f32 v176, v176, v24
    v_mul_f32 v177, v177, v24
    v_mul_f32 v178, v178, v24
    v_mul_f32 v179, v179, v24
    v_mul_f32 v188, v188, v24
    v_mul_f32 v189, v189, v24
    v_mul_f32 v190, v190, v24
    v_mul_f32 v191, v191, v24
    v_mul_f32 v200, v200, v24
    v_mul_f32 v201, v201, v24
    v_mul_f32 v202, v202, v24
    v_mul_f32 v203, v203, v24
    v_mul_f32 v212, v212, v24
    v_mul_f32 v213, v213, v24
    v_mul_f32 v214, v214, v24
    v_mul_f32 v215, v215, v24
    v_mul_f32 v224, v224, v24
    v_mul_f32 v225, v225, v24
    v_mul_f32 v226, v226, v24
    v_mul_f32 v227, v227, v24
    v_mul_f32 v236, v236, v24
    v_mul_f32 v237, v237, v24
    v_mul_f32 v238, v238, v24
    v_mul_f32 v239, v239, v24
    v_mul_f32 v248, v248, v24
    v_mul_f32 v249, v249, v24
    v_mul_f32 v250, v250, v24
    v_mul_f32 v251, v251, v24
    v_mov_b32 v24, v18
    s_nop 1
    v_permlane32_swap_b32 v18, v24
    v_max_f32 v18, v18, v24
    v_mov_b32 v24, v18
    s_nop 1
    v_permlane16_swap_b32 v18, v24
    v_max_f32 v18, v18, v24
    v_mul_f32 v18, s38, v18
    v_max_f32 v18, v18, v7
    v_sub_f32 v24, v7, v18
    v_exp_f32 v24, v24
    v_mov_b32 v7, v18
    v_mul_f32 v10, v10, v24
    v_mul_f32 v120, v120, v24
    v_mul_f32 v121, v121, v24
    v_mul_f32 v122, v122, v24
    v_mul_f32 v123, v123, v24
    v_mul_f32 v132, v132, v24
    v_mul_f32 v133, v133, v24
    v_mul_f32 v134, v134, v24
    v_mul_f32 v135, v135, v24
    v_mul_f32 v144, v144, v24
    v_mul_f32 v145, v145, v24
    v_mul_f32 v146, v146, v24
    v_mul_f32 v147, v147, v24
    v_mul_f32 v156, v156, v24
    v_mul_f32 v157, v157, v24
    v_mul_f32 v158, v158, v24
    v_mul_f32 v159, v159, v24
    v_mul_f32 v168, v168, v24
    v_mul_f32 v169, v169, v24
    v_mul_f32 v170, v170, v24
    v_mul_f32 v171, v171, v24
    v_mul_f32 v180, v180, v24
    v_mul_f32 v181, v181, v24
    v_mul_f32 v182, v182, v24
    v_mul_f32 v183, v183, v24
    v_mul_f32 v192, v192, v24
    v_mul_f32 v193, v193, v24
    v_mul_f32 v194, v194, v24
    v_mul_f32 v195, v195, v24
    v_mul_f32 v204, v204, v24
    v_mul_f32 v205, v205, v24
    v_mul_f32 v206, v206, v24
    v_mul_f32 v207, v207, v24
    v_mul_f32 v216, v216, v24
    v_mul_f32 v217, v217, v24
    v_mul_f32 v218, v218, v24
    v_mul_f32 v219, v219, v24
    v_mul_f32 v228, v228, v24
    v_mul_f32 v229, v229, v24
    v_mul_f32 v230, v230, v24
    v_mul_f32 v231, v231, v24
    v_mul_f32 v240, v240, v24
    v_mul_f32 v241, v241, v24
    v_mul_f32 v242, v242, v24
    v_mul_f32 v243, v243, v24
    v_mul_f32 v252, v252, v24
    v_mul_f32 v253, v253, v24
    v_mul_f32 v254, v254, v24
    v_mul_f32 v255, v255, v24
    s_nop 1
    s_branch attn_kernel_h_back
attn_kernel_light:
    s_nop 1
    s_mov_b32 s61, 0
    s_add_u32 s40, s25, 0
    s_add_u32 m0, s40, 0
    s_nop 0
    buffer_load_dwordx4 v4, s[16:19], s29 offen lds
    s_add_u32 m0, s40, 3968
    s_nop 0
    buffer_load_dwordx4 v4, s[16:19], s29 offen offset:128 lds
    s_add_u32 m0, s40, 7936
    s_nop 0
    buffer_load_dwordx4 v4, s[16:19], s29 offen offset:256 lds
    s_add_u32 s29, s29, 393216
    s_add_u32 s40, s25, 12288
    s_add_u32 m0, s40, 0
    s_nop 0
    buffer_load_dwordx4 v4, s[16:19], s29 offen lds
    s_add_u32 m0, s40, 3968
    s_nop 0
    buffer_load_dwordx4 v4, s[16:19], s29 offen offset:128 lds
    s_add_u32 m0, s40, 7936
    s_nop 0
    buffer_load_dwordx4 v4, s[16:19], s29 offen offset:256 lds
    s_add_u32 s29, s29, 393216
    buffer_load_dwordx4 v[40:43], v5, s[4:7], s26 offen
    s_add_u32 s26, s26, 64
    buffer_load_dwordx4 v[44:47], v5, s[4:7], s27 offen
    s_add_u32 s27, s27, 64
    s_add_u32 s61, s61, 1
    s_add_u32 s40, s25, 24576
    s_add_u32 m0, s40, 0
    s_nop 0
    buffer_load_dwordx4 v4, s[16:19], s29 offen lds
    s_add_u32 m0, s40, 3968
    s_nop 0
    buffer_load_dwordx4 v4, s[16:19], s29 offen offset:128 lds
    s_add_u32 m0, s40, 7936
    s_nop 0
    buffer_load_dwordx4 v4, s[16:19], s29 offen offset:256 lds
    s_add_u32 s29, s29, 393216
    buffer_load_dwordx4 v[48:51], v5, s[4:7], s26 offen
    s_add_u32 s26, s26, 64
    buffer_load_dwordx4 v[52:55], v5, s[4:7], s27 offen
    s_add_u32 s27, s27, 64
    s_add_u32 s61, s61, 1
    s_add_u32 s40, s25, 36864
    s_add_u32 m0, s40, 0
    s_nop 0
    buffer_load_dwordx4 v4, s[16:19], s29 offen lds
    s_add_u32 m0, s40, 3968
    s_nop 0
    buffer_load_dwordx4 v4, s[16:19], s29 offen offset:128 lds
    s_add_u32 m0, s40, 7936
    s_nop 0
    buffer_load_dwordx4 v4, s[16:19], s29 offen offset:256 lds
    s_add_u32 s29, s29, 393216
    buffer_load_dwordx4 v[56:59], v5, s[4:7], s26 offen
    s_add_u32 s26, s26, 64
    buffer_load_dwordx4 v[60:63], v5, s[4:7], s27 offen
    s_add_u32 s27, s27, 64
    s_add_u32 s61, s61, 1
    s_add_u32 s40, s25, 49152
    s_add_u32 m0, s40, 0
    s_nop 0
    buffer_load_dwordx4 v4, s[16:19], s29 offen lds
    s_add_u32 m0, s40, 3968
    s_nop 0
    buffer_load_dwordx4 v4, s[16:19], s29 offen offset:128 lds
    s_add_u32 m0, s40, 7936
    s_nop 0
    buffer_load_dwordx4 v4, s[16:19], s29 offen offset:256 lds
    s_add_u32 s29, s29, 393216
    v_mov_b32 v112, 0
    v_mov_b32 v113, 0
    v_mov_b32 v114, 0
    v_mov_b32 v115, 0
    v_mov_b32 v116, 0
    v_mov_b32 v117, 0
    v_mov_b32 v118, 0
    v_mov_b32 v119, 0
    v_mov_b32 v124, 0
    v_mov_b32 v125, 0
    v_mov_b32 v126, 0
    v_mov_b32 v127, 0
    v_mov_b32 v128, 0
    v_mov_b32 v129, 0
    v_mov_b32 v130, 0
    v_mov_b32 v131, 0
    v_mov_b32 v136, 0
    v_mov_b32 v137, 0
    v_mov_b32 v138, 0
    v_mov_b32 v139, 0
    v_mov_b32 v140, 0
    v_mov_b32 v141, 0
    v_mov_b32 v142, 0
    v_mov_b32 v143, 0
    v_mov_b32 v148, 0
    v_mov_b32 v149, 0
    v_mov_b32 v150, 0
    v_mov_b32 v151, 0
    v_mov_b32 v152, 0
    v_mov_b32 v153, 0
    v_mov_b32 v154, 0
    v_mov_b32 v155, 0
    v_mov_b32 v160, 0
    v_mov_b32 v161, 0
    v_mov_b32 v162, 0
    v_mov_b32 v163, 0
    v_mov_b32 v164, 0
    v_mov_b32 v165, 0
    v_mov_b32 v166, 0
    v_mov_b32 v167, 0
    v_mov_b32 v172, 0
    v_mov_b32 v173, 0
    v_mov_b32 v174, 0
    v_mov_b32 v175, 0
    v_mov_b32 v176, 0
    v_mov_b32 v177, 0
    v_mov_b32 v178, 0
    v_mov_b32 v179, 0
    v_mov_b32 v184, 0
    v_mov_b32 v185, 0
    v_mov_b32 v186, 0
    v_mov_b32 v187, 0
    v_mov_b32 v188, 0
    v_mov_b32 v189, 0
    v_mov_b32 v190, 0
    v_mov_b32 v191, 0
    v_mov_b32 v196, 0
    v_mov_b32 v197, 0
    v_mov_b32 v198, 0
    v_mov_b32 v199, 0
    v_mov_b32 v200, 0
    v_mov_b32 v201, 0
    v_mov_b32 v202, 0
    v_mov_b32 v203, 0
    v_mov_b32 v208, 0
    v_mov_b32 v209, 0
    v_mov_b32 v210, 0
    v_mov_b32 v211, 0
    v_mov_b32 v212, 0
    v_mov_b32 v213, 0
    v_mov_b32 v214, 0
    v_mov_b32 v215, 0
    v_mov_b32 v220, 0
    v_mov_b32 v221, 0
    v_mov_b32 v222, 0
    v_mov_b32 v223, 0
    v_mov_b32 v224, 0
    v_mov_b32 v225, 0
    v_mov_b32 v226, 0
    v_mov_b32 v227, 0
    v_mov_b32 v232, 0
    v_mov_b32 v233, 0
    v_mov_b32 v234, 0
    v_mov_b32 v235, 0
    v_mov_b32 v236, 0
    v_mov_b32 v237, 0
    v_mov_b32 v238, 0
    v_mov_b32 v239, 0
    v_mov_b32 v244, 0
    v_mov_b32 v245, 0
    v_mov_b32 v246, 0
    v_mov_b32 v247, 0
    v_mov_b32 v248, 0
    v_mov_b32 v249, 0
    v_mov_b32 v250, 0
    v_mov_b32 v251, 0
    s_mov_b32 s3, 5
    s_mov_b32 s35, 0
    s_add_u32 s36, s25, 61440
    s_mov_b32 s37, 0
    s_nop 3
attn_kernel_l_qloop:
    s_waitcnt vmcnt(9)
    s_barrier
    s_cmp_lt_u32 s3, 20
    s_cbranch_scc0 attn_kernel_l_kv_23
    s_mov_b64 s[92:93], s[16:17]
    s_mov_b64 s[94:95], s[18:19]
    s_mov_b32 s96, s29
    v_mov_b32 v9, v4
    s_add_u32 s29, s29, 393216
    s_branch attn_kernel_l_dn_25
attn_kernel_l_kv_23:
    s_bitcmp1_b32 s3, 0
    s_cbranch_scc1 attn_kernel_l_v_24
    s_mov_b64 s[92:93], s[8:9]
    s_mov_b64 s[94:95], s[10:11]
    s_mov_b32 s96, s30
    v_mov_b32 v9, v2
    s_add_u32 s30, s30, 12288
    s_branch attn_kernel_l_dn_25
attn_kernel_l_v_24:
    s_mov_b64 s[92:93], s[12:13]
    s_mov_b64 s[94:95], s[14:15]
    s_mov_b32 s96, s32
    v_mov_b32 v9, v3
    s_add_u32 s32, s32, 12288
attn_kernel_l_dn_25:
    s_add_u32 s3, s3, 1
    v_add_u32 v11, s35, v15
    v_xor_b32 v12, 32, v11
    v_xor_b32 v13, 64, v11
    v_xor_b32 v14, 96, v11
    ds_bpermute_b32 v88, v7, v40
    ds_bpermute_b32 v89, v7, v41
    ds_bpermute_b32 v90, v7, v42
    ds_bpermute_b32 v91, v7, v43
    ds_bpermute_b32 v92, v7, v44
    ds_bpermute_b32 v93, v7, v45
    ds_bpermute_b32 v94, v7, v46
    ds_bpermute_b32 v95, v7, v47
    ds_read_b64_tr_b16 v[16:17], v11
    ds_read_b64_tr_b16 v[18:19], v11 offset:512
    ds_read_b64_tr_b16 v[20:21], v12
    ds_read_b64_tr_b16 v[22:23], v12 offset:512
    ds_read_b64_tr_b16 v[24:25], v13
    ds_read_b64_tr_b16 v[26:27], v13 offset:512
    ds_read_b64_tr_b16 v[28:29], v14
    ds_read_b64_tr_b16 v[30:31], v14 offset:512
    ds_read_b64_tr_b16 v[32:33], v11 offset:4096
    ds_read_b64_tr_b16 v[34:35], v11 offset:4608
    s_waitcnt lgkmcnt(8)
    v_mfma_f32_16x16x32_bf16 v[112:115], v[16:19], v[88:91], v[112:115]
    v_mfma_f32_16x16x32_bf16 v[116:119], v[16:19], v[92:95], v[116:119]
    ds_read_b64_tr_b16 v[36:37], v12 offset:4096
    ds_read_b64_tr_b16 v[38:39], v12 offset:4608
    s_waitcnt lgkmcnt(8)
    v_mfma_f32_16x16x32_bf16 v[124:127], v[20:23], v[88:91], v[124:127]
    v_mfma_f32_16x16x32_bf16 v[128:131], v[20:23], v[92:95], v[128:131]
    s_cmp_lt_u32 s61, 20
    s_cbranch_scc0 attn_kernel_l_nx_26
    buffer_load_dwordx4 v[64:67], v5, s[4:7], s26 offen
    s_add_u32 s26, s26, 64
    buffer_load_dwordx4 v[68:71], v5, s[4:7], s27 offen
    s_add_u32 s27, s27, 64
    s_add_u32 s61, s61, 1
attn_kernel_l_nx_26:
    ds_read_b64_tr_b16 v[16:17], v13 offset:4096
    ds_read_b64_tr_b16 v[18:19], v13 offset:4608
    s_waitcnt lgkmcnt(8)
    v_mfma_f32_16x16x32_bf16 v[136:139], v[24:27], v[88:91], v[136:139]
    v_mfma_f32_16x16x32_bf16 v[140:143], v[24:27], v[92:95], v[140:143]
    ds_read_b64_tr_b16 v[20:21], v14 offset:4096
    ds_read_b64_tr_b16 v[22:23], v14 offset:4608
    s_waitcnt lgkmcnt(8)
    v_mfma_f32_16x16x32_bf16 v[148:151], v[28:31], v[88:91], v[148:151]
    v_mfma_f32_16x16x32_bf16 v[152:155], v[28:31], v[92:95], v[152:155]
    ds_read_b64_tr_b16 v[24:25], v11 offset:8192
    ds_read_b64_tr_b16 v[26:27], v11 offset:8704
    s_waitcnt lgkmcnt(8)
    v_mfma_f32_16x16x32_bf16 v[160:163], v[32:35], v[88:91], v[160:163]
    v_mfma_f32_16x16x32_bf16 v[164:167], v[32:35], v[92:95], v[164:167]
    s_add_u32 m0, s36, 0
    s_nop 0
    buffer_load_dwordx4 v9, s[92:95], s96 offen lds
    ds_read_b64_tr_b16 v[28:29], v12 offset:8192
    ds_read_b64_tr_b16 v[30:31], v12 offset:8704
    s_waitcnt lgkmcnt(8)
    v_mfma_f32_16x16x32_bf16 v[172:175], v[36:39], v[88:91], v[172:175]
    v_mfma_f32_16x16x32_bf16 v[176:179], v[36:39], v[92:95], v[176:179]
    ds_read_b64_tr_b16 v[32:33], v13 offset:8192
    ds_read_b64_tr_b16 v[34:35], v13 offset:8704
    s_waitcnt lgkmcnt(8)
    v_mfma_f32_16x16x32_bf16 v[184:187], v[16:19], v[88:91], v[184:187]
    v_mfma_f32_16x16x32_bf16 v[188:191], v[16:19], v[92:95], v[188:191]
    s_add_u32 m0, s36, 3968
    s_nop 0
    buffer_load_dwordx4 v9, s[92:95], s96 offen offset:128 lds
    ds_read_b64_tr_b16 v[36:37], v14 offset:8192
    ds_read_b64_tr_b16 v[38:39], v14 offset:8704
    s_waitcnt lgkmcnt(8)
    v_mfma_f32_16x16x32_bf16 v[196:199], v[20:23], v[88:91], v[196:199]
    v_mfma_f32_16x16x32_bf16 v[200:203], v[20:23], v[92:95], v[200:203]
    s_waitcnt lgkmcnt(6)
    v_mfma_f32_16x16x32_bf16 v[208:211], v[24:27], v[88:91], v[208:211]
    v_mfma_f32_16x16x32_bf16 v[212:215], v[24:27], v[92:95], v[212:215]
    s_add_u32 m0, s36, 7936
    s_nop 0
    buffer_load_dwordx4 v9, s[92:95], s96 offen offset:256 lds
    s_waitcnt lgkmcnt(4)
    v_mfma_f32_16x16x32_bf16 v[220:223], v[28:31], v[88:91], v[220:223]
    v_mfma_f32_16x16x32_bf16 v[224:227], v[28:31], v[92:95], v[224:227]
    s_waitcnt lgkmcnt(2)
    v_mfma_f32_16x16x32_bf16 v[232:235], v[32:35], v[88:91], v[232:235]
    v_mfma_f32_16x16x32_bf16 v[236:239], v[32:35], v[92:95], v[236:239]
    s_waitcnt lgkmcnt(0)
    v_mfma_f32_16x16x32_bf16 v[244:247], v[36:39], v[88:91], v[244:247]
    v_mfma_f32_16x16x32_bf16 v[248:251], v[36:39], v[92:95], v[248:251]
    s_add_u32 s36, s35, s25
    s_add_u32 s35, s35, 12288
    s_cmp_eq_u32 s35, 73728
    s_cselect_b32 s35, 0, s35
    s_waitcnt vmcnt(9)
    s_barrier
    s_cmp_lt_u32 s3, 20
    s_cbranch_scc0 attn_kernel_l_kv_27
    s_mov_b64 s[92:93], s[16:17]
    s_mov_b64 s[94:95], s[18:19]
    s_mov_b32 s96, s29
    v_mov_b32 v9, v4
    s_add_u32 s29, s29, 393216
    s_branch attn_kernel_l_dn_29
attn_kernel_l_kv_27:
    s_bitcmp1_b32 s3, 0
    s_cbranch_scc1 attn_kernel_l_v_28
    s_mov_b64 s[92:93], s[8:9]
    s_mov_b64 s[94:95], s[10:11]
    s_mov_b32 s96, s30
    v_mov_b32 v9, v2
    s_add_u32 s30, s30, 12288
    s_branch attn_kernel_l_dn_29
attn_kernel_l_v_28:
    s_mov_b64 s[92:93], s[12:13]
    s_mov_b64 s[94:95], s[14:15]
    s_mov_b32 s96, s32
    v_mov_b32 v9, v3
    s_add_u32 s32, s32, 12288
attn_kernel_l_dn_29:
    s_add_u32 s3, s3, 1
    v_add_u32 v11, s35, v15
    v_xor_b32 v12, 32, v11
    v_xor_b32 v13, 64, v11
    v_xor_b32 v14, 96, v11
    ds_bpermute_b32 v88, v7, v48
    ds_bpermute_b32 v89, v7, v49
    ds_bpermute_b32 v90, v7, v50
    ds_bpermute_b32 v91, v7, v51
    ds_bpermute_b32 v92, v7, v52
    ds_bpermute_b32 v93, v7, v53
    ds_bpermute_b32 v94, v7, v54
    ds_bpermute_b32 v95, v7, v55
    ds_read_b64_tr_b16 v[16:17], v11
    ds_read_b64_tr_b16 v[18:19], v11 offset:512
    ds_read_b64_tr_b16 v[20:21], v12
    ds_read_b64_tr_b16 v[22:23], v12 offset:512
    ds_read_b64_tr_b16 v[24:25], v13
    ds_read_b64_tr_b16 v[26:27], v13 offset:512
    ds_read_b64_tr_b16 v[28:29], v14
    ds_read_b64_tr_b16 v[30:31], v14 offset:512
    ds_read_b64_tr_b16 v[32:33], v11 offset:4096
    ds_read_b64_tr_b16 v[34:35], v11 offset:4608
    s_waitcnt lgkmcnt(8)
    v_mfma_f32_16x16x32_bf16 v[112:115], v[16:19], v[88:91], v[112:115]
    v_mfma_f32_16x16x32_bf16 v[116:119], v[16:19], v[92:95], v[116:119]
    ds_read_b64_tr_b16 v[36:37], v12 offset:4096
    ds_read_b64_tr_b16 v[38:39], v12 offset:4608
    s_waitcnt lgkmcnt(8)
    v_mfma_f32_16x16x32_bf16 v[124:127], v[20:23], v[88:91], v[124:127]
    v_mfma_f32_16x16x32_bf16 v[128:131], v[20:23], v[92:95], v[128:131]
    s_cmp_lt_u32 s61, 20
    s_cbranch_scc0 attn_kernel_l_nx_30
    buffer_load_dwordx4 v[40:43], v5, s[4:7], s26 offen
    s_add_u32 s26, s26, 64
    buffer_load_dwordx4 v[44:47], v5, s[4:7], s27 offen
    s_add_u32 s27, s27, 64
    s_add_u32 s61, s61, 1
attn_kernel_l_nx_30:
    ds_read_b64_tr_b16 v[16:17], v13 offset:4096
    ds_read_b64_tr_b16 v[18:19], v13 offset:4608
    s_waitcnt lgkmcnt(8)
    v_mfma_f32_16x16x32_bf16 v[136:139], v[24:27], v[88:91], v[136:139]
    v_mfma_f32_16x16x32_bf16 v[140:143], v[24:27], v[92:95], v[140:143]
    ds_read_b64_tr_b16 v[20:21], v14 offset:4096
    ds_read_b64_tr_b16 v[22:23], v14 offset:4608
    s_waitcnt lgkmcnt(8)
    v_mfma_f32_16x16x32_bf16 v[148:151], v[28:31], v[88:91], v[148:151]
    v_mfma_f32_16x16x32_bf16 v[152:155], v[28:31], v[92:95], v[152:155]
    ds_read_b64_tr_b16 v[24:25], v11 offset:8192
    ds_read_b64_tr_b16 v[26:27], v11 offset:8704
    s_waitcnt lgkmcnt(8)
    v_mfma_f32_16x16x32_bf16 v[160:163], v[32:35], v[88:91], v[160:163]
    v_mfma_f32_16x16x32_bf16 v[164:167], v[32:35], v[92:95], v[164:167]
    s_add_u32 m0, s36, 0
    s_nop 0
    buffer_load_dwordx4 v9, s[92:95], s96 offen lds
    ds_read_b64_tr_b16 v[28:29], v12 offset:8192
    ds_read_b64_tr_b16 v[30:31], v12 offset:8704
    s_waitcnt lgkmcnt(8)
    v_mfma_f32_16x16x32_bf16 v[172:175], v[36:39], v[88:91], v[172:175]
    v_mfma_f32_16x16x32_bf16 v[176:179], v[36:39], v[92:95], v[176:179]
    ds_read_b64_tr_b16 v[32:33], v13 offset:8192
    ds_read_b64_tr_b16 v[34:35], v13 offset:8704
    s_waitcnt lgkmcnt(8)
    v_mfma_f32_16x16x32_bf16 v[184:187], v[16:19], v[88:91], v[184:187]
    v_mfma_f32_16x16x32_bf16 v[188:191], v[16:19], v[92:95], v[188:191]
    s_add_u32 m0, s36, 3968
    s_nop 0
    buffer_load_dwordx4 v9, s[92:95], s96 offen offset:128 lds
    ds_read_b64_tr_b16 v[36:37], v14 offset:8192
    ds_read_b64_tr_b16 v[38:39], v14 offset:8704
    s_waitcnt lgkmcnt(8)
    v_mfma_f32_16x16x32_bf16 v[196:199], v[20:23], v[88:91], v[196:199]
    v_mfma_f32_16x16x32_bf16 v[200:203], v[20:23], v[92:95], v[200:203]
    s_waitcnt lgkmcnt(6)
    v_mfma_f32_16x16x32_bf16 v[208:211], v[24:27], v[88:91], v[208:211]
    v_mfma_f32_16x16x32_bf16 v[212:215], v[24:27], v[92:95], v[212:215]
    s_add_u32 m0, s36, 7936
    s_nop 0
    buffer_load_dwordx4 v9, s[92:95], s96 offen offset:256 lds
    s_waitcnt lgkmcnt(4)
    v_mfma_f32_16x16x32_bf16 v[220:223], v[28:31], v[88:91], v[220:223]
    v_mfma_f32_16x16x32_bf16 v[224:227], v[28:31], v[92:95], v[224:227]
    s_waitcnt lgkmcnt(2)
    v_mfma_f32_16x16x32_bf16 v[232:235], v[32:35], v[88:91], v[232:235]
    v_mfma_f32_16x16x32_bf16 v[236:239], v[32:35], v[92:95], v[236:239]
    s_waitcnt lgkmcnt(0)
    v_mfma_f32_16x16x32_bf16 v[244:247], v[36:39], v[88:91], v[244:247]
    v_mfma_f32_16x16x32_bf16 v[248:251], v[36:39], v[92:95], v[248:251]
    s_add_u32 s36, s35, s25
    s_add_u32 s35, s35, 12288
    s_cmp_eq_u32 s35, 73728
    s_cselect_b32 s35, 0, s35
    s_waitcnt vmcnt(9)
    s_barrier
    s_cmp_lt_u32 s3, 20
    s_cbranch_scc0 attn_kernel_l_kv_31
    s_mov_b64 s[92:93], s[16:17]
    s_mov_b64 s[94:95], s[18:19]
    s_mov_b32 s96, s29
    v_mov_b32 v9, v4
    s_add_u32 s29, s29, 393216
    s_branch attn_kernel_l_dn_33
attn_kernel_l_kv_31:
    s_bitcmp1_b32 s3, 0
    s_cbranch_scc1 attn_kernel_l_v_32
    s_mov_b64 s[92:93], s[8:9]
    s_mov_b64 s[94:95], s[10:11]
    s_mov_b32 s96, s30
    v_mov_b32 v9, v2
    s_add_u32 s30, s30, 12288
    s_branch attn_kernel_l_dn_33
attn_kernel_l_v_32:
    s_mov_b64 s[92:93], s[12:13]
    s_mov_b64 s[94:95], s[14:15]
    s_mov_b32 s96, s32
    v_mov_b32 v9, v3
    s_add_u32 s32, s32, 12288
attn_kernel_l_dn_33:
    s_add_u32 s3, s3, 1
    v_add_u32 v11, s35, v15
    v_xor_b32 v12, 32, v11
    v_xor_b32 v13, 64, v11
    v_xor_b32 v14, 96, v11
    ds_bpermute_b32 v88, v7, v56
    ds_bpermute_b32 v89, v7, v57
    ds_bpermute_b32 v90, v7, v58
    ds_bpermute_b32 v91, v7, v59
    ds_bpermute_b32 v92, v7, v60
    ds_bpermute_b32 v93, v7, v61
    ds_bpermute_b32 v94, v7, v62
    ds_bpermute_b32 v95, v7, v63
    ds_read_b64_tr_b16 v[16:17], v11
    ds_read_b64_tr_b16 v[18:19], v11 offset:512
    ds_read_b64_tr_b16 v[20:21], v12
    ds_read_b64_tr_b16 v[22:23], v12 offset:512
    ds_read_b64_tr_b16 v[24:25], v13
    ds_read_b64_tr_b16 v[26:27], v13 offset:512
    ds_read_b64_tr_b16 v[28:29], v14
    ds_read_b64_tr_b16 v[30:31], v14 offset:512
    ds_read_b64_tr_b16 v[32:33], v11 offset:4096
    ds_read_b64_tr_b16 v[34:35], v11 offset:4608
    s_waitcnt lgkmcnt(8)
    v_mfma_f32_16x16x32_bf16 v[112:115], v[16:19], v[88:91], v[112:115]
    v_mfma_f32_16x16x32_bf16 v[116:119], v[16:19], v[92:95], v[116:119]
    ds_read_b64_tr_b16 v[36:37], v12 offset:4096
    ds_read_b64_tr_b16 v[38:39], v12 offset:4608
    s_waitcnt lgkmcnt(8)
    v_mfma_f32_16x16x32_bf16 v[124:127], v[20:23], v[88:91], v[124:127]
    v_mfma_f32_16x16x32_bf16 v[128:131], v[20:23], v[92:95], v[128:131]
    s_cmp_lt_u32 s61, 20
    s_cbranch_scc0 attn_kernel_l_nx_34
    buffer_load_dwordx4 v[48:51], v5, s[4:7], s26 offen
    s_add_u32 s26, s26, 64
    buffer_load_dwordx4 v[52:55], v5, s[4:7], s27 offen
    s_add_u32 s27, s27, 64
    s_add_u32 s61, s61, 1
attn_kernel_l_nx_34:
    ds_read_b64_tr_b16 v[16:17], v13 offset:4096
    ds_read_b64_tr_b16 v[18:19], v13 offset:4608
    s_waitcnt lgkmcnt(8)
    v_mfma_f32_16x16x32_bf16 v[136:139], v[24:27], v[88:91], v[136:139]
    v_mfma_f32_16x16x32_bf16 v[140:143], v[24:27], v[92:95], v[140:143]
    ds_read_b64_tr_b16 v[20:21], v14 offset:4096
    ds_read_b64_tr_b16 v[22:23], v14 offset:4608
    s_waitcnt lgkmcnt(8)
    v_mfma_f32_16x16x32_bf16 v[148:151], v[28:31], v[88:91], v[148:151]
    v_mfma_f32_16x16x32_bf16 v[152:155], v[28:31], v[92:95], v[152:155]
    ds_read_b64_tr_b16 v[24:25], v11 offset:8192
    ds_read_b64_tr_b16 v[26:27], v11 offset:8704
    s_waitcnt lgkmcnt(8)
    v_mfma_f32_16x16x32_bf16 v[160:163], v[32:35], v[88:91], v[160:163]
    v_mfma_f32_16x16x32_bf16 v[164:167], v[32:35], v[92:95], v[164:167]
    s_add_u32 m0, s36, 0
    s_nop 0
    buffer_load_dwordx4 v9, s[92:95], s96 offen lds
    ds_read_b64_tr_b16 v[28:29], v12 offset:8192
    ds_read_b64_tr_b16 v[30:31], v12 offset:8704
    s_waitcnt lgkmcnt(8)
    v_mfma_f32_16x16x32_bf16 v[172:175], v[36:39], v[88:91], v[172:175]
    v_mfma_f32_16x16x32_bf16 v[176:179], v[36:39], v[92:95], v[176:179]
    ds_read_b64_tr_b16 v[32:33], v13 offset:8192
    ds_read_b64_tr_b16 v[34:35], v13 offset:8704
    s_waitcnt lgkmcnt(8)
    v_mfma_f32_16x16x32_bf16 v[184:187], v[16:19], v[88:91], v[184:187]
    v_mfma_f32_16x16x32_bf16 v[188:191], v[16:19], v[92:95], v[188:191]
    s_add_u32 m0, s36, 3968
    s_nop 0
    buffer_load_dwordx4 v9, s[92:95], s96 offen offset:128 lds
    ds_read_b64_tr_b16 v[36:37], v14 offset:8192
    ds_read_b64_tr_b16 v[38:39], v14 offset:8704
    s_waitcnt lgkmcnt(8)
    v_mfma_f32_16x16x32_bf16 v[196:199], v[20:23], v[88:91], v[196:199]
    v_mfma_f32_16x16x32_bf16 v[200:203], v[20:23], v[92:95], v[200:203]
    s_waitcnt lgkmcnt(6)
    v_mfma_f32_16x16x32_bf16 v[208:211], v[24:27], v[88:91], v[208:211]
    v_mfma_f32_16x16x32_bf16 v[212:215], v[24:27], v[92:95], v[212:215]
    s_add_u32 m0, s36, 7936
    s_nop 0
    buffer_load_dwordx4 v9, s[92:95], s96 offen offset:256 lds
    s_waitcnt lgkmcnt(4)
    v_mfma_f32_16x16x32_bf16 v[220:223], v[28:31], v[88:91], v[220:223]
    v_mfma_f32_16x16x32_bf16 v[224:227], v[28:31], v[92:95], v[224:227]
    s_waitcnt lgkmcnt(2)
    v_mfma_f32_16x16x32_bf16 v[232:235], v[32:35], v[88:91], v[232:235]
    v_mfma_f32_16x16x32_bf16 v[236:239], v[32:35], v[92:95], v[236:239]
    s_waitcnt lgkmcnt(0)
    v_mfma_f32_16x16x32_bf16 v[244:247], v[36:39], v[88:91], v[244:247]
    v_mfma_f32_16x16x32_bf16 v[248:251], v[36:39], v[92:95], v[248:251]
    s_add_u32 s36, s35, s25
    s_add_u32 s35, s35, 12288
    s_cmp_eq_u32 s35, 73728
    s_cselect_b32 s35, 0, s35
    s_waitcnt vmcnt(9)
    s_barrier
    s_cmp_lt_u32 s3, 20
    s_cbranch_scc0 attn_kernel_l_kv_35
    s_mov_b64 s[92:93], s[16:17]
    s_mov_b64 s[94:95], s[18:19]
    s_mov_b32 s96, s29
    v_mov_b32 v9, v4
    s_add_u32 s29, s29, 393216
    s_branch attn_kernel_l_dn_37
attn_kernel_l_kv_35:
    s_bitcmp1_b32 s3, 0
    s_cbranch_scc1 attn_kernel_l_v_36
    s_mov_b64 s[92:93], s[8:9]
    s_mov_b64 s[94:95], s[10:11]
    s_mov_b32 s96, s30
    v_mov_b32 v9, v2
    s_add_u32 s30, s30, 12288
    s_branch attn_kernel_l_dn_37
attn_kernel_l_v_36:
    s_mov_b64 s[92:93], s[12:13]
    s_mov_b64 s[94:95], s[14:15]
    s_mov_b32 s96, s32
    v_mov_b32 v9, v3
    s_add_u32 s32, s32, 12288
attn_kernel_l_dn_37:
    s_add_u32 s3, s3, 1
    v_add_u32 v11, s35, v15
    v_xor_b32 v12, 32, v11
    v_xor_b32 v13, 64, v11
    v_xor_b32 v14, 96, v11
    ds_bpermute_b32 v88, v7, v64
    ds_bpermute_b32 v89, v7, v65
    ds_bpermute_b32 v90, v7, v66
    ds_bpermute_b32 v91, v7, v67
    ds_bpermute_b32 v92, v7, v68
    ds_bpermute_b32 v93, v7, v69
    ds_bpermute_b32 v94, v7, v70
    ds_bpermute_b32 v95, v7, v71
    ds_read_b64_tr_b16 v[16:17], v11
    ds_read_b64_tr_b16 v[18:19], v11 offset:512
    ds_read_b64_tr_b16 v[20:21], v12
    ds_read_b64_tr_b16 v[22:23], v12 offset:512
    ds_read_b64_tr_b16 v[24:25], v13
    ds_read_b64_tr_b16 v[26:27], v13 offset:512
    ds_read_b64_tr_b16 v[28:29], v14
    ds_read_b64_tr_b16 v[30:31], v14 offset:512
    ds_read_b64_tr_b16 v[32:33], v11 offset:4096
    ds_read_b64_tr_b16 v[34:35], v11 offset:4608
    s_waitcnt lgkmcnt(8)
    v_mfma_f32_16x16x32_bf16 v[112:115], v[16:19], v[88:91], v[112:115]
    v_mfma_f32_16x16x32_bf16 v[116:119], v[16:19], v[92:95], v[116:119]
    ds_read_b64_tr_b16 v[36:37], v12 offset:4096
    ds_read_b64_tr_b16 v[38:39], v12 offset:4608
    s_waitcnt lgkmcnt(8)
    v_mfma_f32_16x16x32_bf16 v[124:127], v[20:23], v[88:91], v[124:127]
    v_mfma_f32_16x16x32_bf16 v[128:131], v[20:23], v[92:95], v[128:131]
    s_cmp_lt_u32 s61, 20
    s_cbranch_scc0 attn_kernel_l_nx_38
    buffer_load_dwordx4 v[56:59], v5, s[4:7], s26 offen
    s_add_u32 s26, s26, 64
    buffer_load_dwordx4 v[60:63], v5, s[4:7], s27 offen
    s_add_u32 s27, s27, 64
    s_add_u32 s61, s61, 1
attn_kernel_l_nx_38:
    ds_read_b64_tr_b16 v[16:17], v13 offset:4096
    ds_read_b64_tr_b16 v[18:19], v13 offset:4608
    s_waitcnt lgkmcnt(8)
    v_mfma_f32_16x16x32_bf16 v[136:139], v[24:27], v[88:91], v[136:139]
    v_mfma_f32_16x16x32_bf16 v[140:143], v[24:27], v[92:95], v[140:143]
    ds_read_b64_tr_b16 v[20:21], v14 offset:4096
    ds_read_b64_tr_b16 v[22:23], v14 offset:4608
    s_waitcnt lgkmcnt(8)
    v_mfma_f32_16x16x32_bf16 v[148:151], v[28:31], v[88:91], v[148:151]
    v_mfma_f32_16x16x32_bf16 v[152:155], v[28:31], v[92:95], v[152:155]
    ds_read_b64_tr_b16 v[24:25], v11 offset:8192
    ds_read_b64_tr_b16 v[26:27], v11 offset:8704
    s_waitcnt lgkmcnt(8)
    v_mfma_f32_16x16x32_bf16 v[160:163], v[32:35], v[88:91], v[160:163]
    v_mfma_f32_16x16x32_bf16 v[164:167], v[32:35], v[92:95], v[164:167]
    s_add_u32 m0, s36, 0
    s_nop 0
    buffer_load_dwordx4 v9, s[92:95], s96 offen lds
    ds_read_b64_tr_b16 v[28:29], v12 offset:8192
    ds_read_b64_tr_b16 v[30:31], v12 offset:8704
    s_waitcnt lgkmcnt(8)
    v_mfma_f32_16x16x32_bf16 v[172:175], v[36:39], v[88:91], v[172:175]
    v_mfma_f32_16x16x32_bf16 v[176:179], v[36:39], v[92:95], v[176:179]
    ds_read_b64_tr_b16 v[32:33], v13 offset:8192
    ds_read_b64_tr_b16 v[34:35], v13 offset:8704
    s_waitcnt lgkmcnt(8)
    v_mfma_f32_16x16x32_bf16 v[184:187], v[16:19], v[88:91], v[184:187]
    v_mfma_f32_16x16x32_bf16 v[188:191], v[16:19], v[92:95], v[188:191]
    s_add_u32 m0, s36, 3968
    s_nop 0
    buffer_load_dwordx4 v9, s[92:95], s96 offen offset:128 lds
    ds_read_b64_tr_b16 v[36:37], v14 offset:8192
    ds_read_b64_tr_b16 v[38:39], v14 offset:8704
    s_waitcnt lgkmcnt(8)
    v_mfma_f32_16x16x32_bf16 v[196:199], v[20:23], v[88:91], v[196:199]
    v_mfma_f32_16x16x32_bf16 v[200:203], v[20:23], v[92:95], v[200:203]
    s_waitcnt lgkmcnt(6)
    v_mfma_f32_16x16x32_bf16 v[208:211], v[24:27], v[88:91], v[208:211]
    v_mfma_f32_16x16x32_bf16 v[212:215], v[24:27], v[92:95], v[212:215]
    s_add_u32 m0, s36, 7936
    s_nop 0
    buffer_load_dwordx4 v9, s[92:95], s96 offen offset:256 lds
    s_waitcnt lgkmcnt(4)
    v_mfma_f32_16x16x32_bf16 v[220:223], v[28:31], v[88:91], v[220:223]
    v_mfma_f32_16x16x32_bf16 v[224:227], v[28:31], v[92:95], v[224:227]
    s_waitcnt lgkmcnt(2)
    v_mfma_f32_16x16x32_bf16 v[232:235], v[32:35], v[88:91], v[232:235]
    v_mfma_f32_16x16x32_bf16 v[236:239], v[32:35], v[92:95], v[236:239]
    s_waitcnt lgkmcnt(0)
    v_mfma_f32_16x16x32_bf16 v[244:247], v[36:39], v[88:91], v[244:247]
    v_mfma_f32_16x16x32_bf16 v[248:251], v[36:39], v[92:95], v[248:251]
    s_add_u32 s36, s35, s25
    s_add_u32 s35, s35, 12288
    s_cmp_eq_u32 s35, 73728
    s_cselect_b32 s35, 0, s35
    s_add_u32 s37, s37, 1
    s_cmp_lt_u32 s37, 5
    s_cbranch_scc1 attn_kernel_l_qloop
    v_lshlrev_b32 v4, 4, v6
    v_add_u32 v4, 73728, v4
    v_cvt_pk_bf16_f32 v64, v112, v113
    v_cvt_pk_bf16_f32 v65, v114, v115
    v_cvt_pk_bf16_f32 v66, v124, v125
    v_cvt_pk_bf16_f32 v67, v126, v127
    s_nop 0
    v_permlane32_swap_b32 v64, v66
    v_permlane32_swap_b32 v65, v67
    s_nop 0
    v_permlane16_swap_b32 v64, v66
    v_permlane16_swap_b32 v65, v67
    v_cvt_pk_bf16_f32 v68, v136, v137
    v_cvt_pk_bf16_f32 v69, v138, v139
    v_cvt_pk_bf16_f32 v70, v148, v149
    v_cvt_pk_bf16_f32 v71, v150, v151
    s_nop 0
    v_permlane32_swap_b32 v68, v70
    v_permlane32_swap_b32 v69, v71
    s_nop 0
    v_permlane16_swap_b32 v68, v70
    v_permlane16_swap_b32 v69, v71
    v_cvt_pk_bf16_f32 v72, v160, v161
    v_cvt_pk_bf16_f32 v73, v162, v163
    v_cvt_pk_bf16_f32 v74, v172, v173
    v_cvt_pk_bf16_f32 v75, v174, v175
    s_nop 0
    v_permlane32_swap_b32 v72, v74
    v_permlane32_swap_b32 v73, v75
    s_nop 0
    v_permlane16_swap_b32 v72, v74
    v_permlane16_swap_b32 v73, v75
    v_cvt_pk_bf16_f32 v76, v184, v185
    v_cvt_pk_bf16_f32 v77, v186, v187
    v_cvt_pk_bf16_f32 v78, v196, v197
    v_cvt_pk_bf16_f32 v79, v198, v199
    s_nop 0
    v_permlane32_swap_b32 v76, v78
    v_permlane32_swap_b32 v77, v79
    s_nop 0
    v_permlane16_swap_b32 v76, v78
    v_permlane16_swap_b32 v77, v79
    v_cvt_pk_bf16_f32 v80, v208, v209
    v_cvt_pk_bf16_f32 v81, v210, v211
    v_cvt_pk_bf16_f32 v82, v220, v221
    v_cvt_pk_bf16_f32 v83, v222, v223
    s_nop 0
    v_permlane32_swap_b32 v80, v82
    v_permlane32_swap_b32 v81, v83
    s_nop 0
    v_permlane16_swap_b32 v80, v82
    v_permlane16_swap_b32 v81, v83
    v_cvt_pk_bf16_f32 v84, v232, v233
    v_cvt_pk_bf16_f32 v85, v234, v235
    v_cvt_pk_bf16_f32 v86, v244, v245
    v_cvt_pk_bf16_f32 v87, v246, v247
    s_nop 0
    v_permlane32_swap_b32 v84, v86
    v_permlane32_swap_b32 v85, v87
    s_nop 0
    v_permlane16_swap_b32 v84, v86
    v_permlane16_swap_b32 v85, v87
    v_cvt_pk_bf16_f32 v88, v116, v117
    v_cvt_pk_bf16_f32 v89, v118, v119
    v_cvt_pk_bf16_f32 v90, v128, v129
    v_cvt_pk_bf16_f32 v91, v130, v131
    s_nop 0
    v_permlane32_swap_b32 v88, v90
    v_permlane32_swap_b32 v89, v91
    s_nop 0
    v_permlane16_swap_b32 v88, v90
    v_permlane16_swap_b32 v89, v91
    v_cvt_pk_bf16_f32 v92, v140, v141
    v_cvt_pk_bf16_f32 v93, v142, v143
    v_cvt_pk_bf16_f32 v94, v152, v153
    v_cvt_pk_bf16_f32 v95, v154, v155
    s_nop 0
    v_permlane32_swap_b32 v92, v94
    v_permlane32_swap_b32 v93, v95
    s_nop 0
    v_permlane16_swap_b32 v92, v94
    v_permlane16_swap_b32 v93, v95
    v_cvt_pk_bf16_f32 v96, v164, v165
    v_cvt_pk_bf16_f32 v97, v166, v167
    v_cvt_pk_bf16_f32 v98, v176, v177
    v_cvt_pk_bf16_f32 v99, v178, v179
    s_nop 0
    v_permlane32_swap_b32 v96, v98
    v_permlane32_swap_b32 v97, v99
    s_nop 0
    v_permlane16_swap_b32 v96, v98
    v_permlane16_swap_b32 v97, v99
    v_cvt_pk_bf16_f32 v100, v188, v189
    v_cvt_pk_bf16_f32 v101, v190, v191
    v_cvt_pk_bf16_f32 v102, v200, v201
    v_cvt_pk_bf16_f32 v103, v202, v203
    s_nop 0
    v_permlane32_swap_b32 v100, v102
    v_permlane32_swap_b32 v101, v103
    s_nop 0
    v_permlane16_swap_b32 v100, v102
    v_permlane16_swap_b32 v101, v103
    v_cvt_pk_bf16_f32 v104, v212, v213
    v_cvt_pk_bf16_f32 v105, v214, v215
    v_cvt_pk_bf16_f32 v106, v224, v225
    v_cvt_pk_bf16_f32 v107, v226, v227
    s_nop 0
    v_permlane32_swap_b32 v104, v106
    v_permlane32_swap_b32 v105, v107
    s_nop 0
    v_permlane16_swap_b32 v104, v106
    v_permlane16_swap_b32 v105, v107
    v_cvt_pk_bf16_f32 v108, v236, v237
    v_cvt_pk_bf16_f32 v109, v238, v239
    v_cvt_pk_bf16_f32 v110, v248, v249
    v_cvt_pk_bf16_f32 v111, v250, v251
    s_nop 0
    v_permlane32_swap_b32 v108, v110
    v_permlane32_swap_b32 v109, v111
    s_nop 0
    v_permlane16_swap_b32 v108, v110
    v_permlane16_swap_b32 v109, v111
    v_mov_b32 v112, 0
    v_mov_b32 v113, 0
    v_mov_b32 v114, 0
    v_mov_b32 v115, 0
    v_mov_b32 v116, 0
    v_mov_b32 v117, 0
    v_mov_b32 v118, 0
    v_mov_b32 v119, 0
    v_mov_b32 v124, 0
    v_mov_b32 v125, 0
    v_mov_b32 v126, 0
    v_mov_b32 v127, 0
    v_mov_b32 v128, 0
    v_mov_b32 v129, 0
    v_mov_b32 v130, 0
    v_mov_b32 v131, 0
    v_mov_b32 v136, 0
    v_mov_b32 v137, 0
    v_mov_b32 v138, 0
    v_mov_b32 v139, 0
    v_mov_b32 v140, 0
    v_mov_b32 v141, 0
    v_mov_b32 v142, 0
    v_mov_b32 v143, 0
    v_mov_b32 v148, 0
    v_mov_b32 v149, 0
    v_mov_b32 v150, 0
    v_mov_b32 v151, 0
    v_mov_b32 v152, 0
    v_mov_b32 v153, 0
    v_mov_b32 v154, 0
    v_mov_b32 v155, 0
    v_mov_b32 v160, 0
    v_mov_b32 v161, 0
    v_mov_b32 v162, 0
    v_mov_b32 v163, 0
    v_mov_b32 v164, 0
    v_mov_b32 v165, 0
    v_mov_b32 v166, 0
    v_mov_b32 v167, 0
    v_mov_b32 v172, 0
    v_mov_b32 v173, 0
    v_mov_b32 v174, 0
    v_mov_b32 v175, 0
    v_mov_b32 v176, 0
    v_mov_b32 v177, 0
    v_mov_b32 v178, 0
    v_mov_b32 v179, 0
    v_mov_b32 v184, 0
    v_mov_b32 v185, 0
    v_mov_b32 v186, 0
    v_mov_b32 v187, 0
    v_mov_b32 v188, 0
    v_mov_b32 v189, 0
    v_mov_b32 v190, 0
    v_mov_b32 v191, 0
    v_mov_b32 v196, 0
    v_mov_b32 v197, 0
    v_mov_b32 v198, 0
    v_mov_b32 v199, 0
    v_mov_b32 v200, 0
    v_mov_b32 v201, 0
    v_mov_b32 v202, 0
    v_mov_b32 v203, 0
    v_mov_b32 v208, 0
    v_mov_b32 v209, 0
    v_mov_b32 v210, 0
    v_mov_b32 v211, 0
    v_mov_b32 v212, 0
    v_mov_b32 v213, 0
    v_mov_b32 v214, 0
    v_mov_b32 v215, 0
    v_mov_b32 v220, 0
    v_mov_b32 v221, 0
    v_mov_b32 v222, 0
    v_mov_b32 v223, 0
    v_mov_b32 v224, 0
    v_mov_b32 v225, 0
    v_mov_b32 v226, 0
    v_mov_b32 v227, 0
    v_mov_b32 v232, 0
    v_mov_b32 v233, 0
    v_mov_b32 v234, 0
    v_mov_b32 v235, 0
    v_mov_b32 v236, 0
    v_mov_b32 v237, 0
    v_mov_b32 v238, 0
    v_mov_b32 v239, 0
    v_mov_b32 v244, 0
    v_mov_b32 v245, 0
    v_mov_b32 v246, 0
    v_mov_b32 v247, 0
    v_mov_b32 v248, 0
    v_mov_b32 v249, 0
    v_mov_b32 v250, 0
    v_mov_b32 v251, 0
    v_mov_b32 v5, 4048155338
    v_mov_b32 v8, 0
    v_mov_b32 v6, 4048155338
    v_mov_b32 v9, 0
    s_mov_b32 s37, 0
    s_nop 3
attn_kernel_l_loop:
    s_waitcnt vmcnt(12)
    s_barrier
    s_cmp_lt_u32 s32, s33
    s_cselect_b32 s41, s32, s34
    s_add_u32 s32, s32, 12288
    v_add_u32 v11, s35, v0
    v_xor_b32 v12, 64, v11
    ds_read_b128 v[16:19], v11
    ds_read_b128 v[20:23], v11 offset:2048
    ds_read_b128 v[24:27], v12
    ds_read_b128 v[28:31], v12 offset:2048
    ds_read_b128 v[32:35], v11 offset:4096
    ds_read_b128 v[36:39], v11 offset:6144
    s_waitcnt lgkmcnt(4)
    v_mfma_f32_16x16x32_bf16 v[40:43], v[16:19], v[64:67], 0
    v_mfma_f32_16x16x32_bf16 v[44:47], v[16:19], v[88:91], 0
    v_mfma_f32_16x16x32_bf16 v[52:55], v[20:23], v[64:67], 0
    v_mfma_f32_16x16x32_bf16 v[56:59], v[20:23], v[88:91], 0
    ds_read_b128 v[16:19], v12 offset:4096
    ds_read_b128 v[20:23], v12 offset:6144
    s_add_u32 m0, s36, 0
    s_nop 0
    buffer_load_dwordx4 v3, s[12:15], s41 offen nt lds
    s_waitcnt lgkmcnt(4)
    v_mfma_f32_16x16x32_bf16 v[40:43], v[24:27], v[68:71], v[40:43]
    v_mfma_f32_16x16x32_bf16 v[44:47], v[24:27], v[92:95], v[44:47]
    v_mfma_f32_16x16x32_bf16 v[52:55], v[28:31], v[68:71], v[52:55]
    v_mfma_f32_16x16x32_bf16 v[56:59], v[28:31], v[92:95], v[56:59]
    ds_read_b128 v[24:27], v11 offset:8192
    ds_read_b128 v[28:31], v11 offset:10240
    s_waitcnt lgkmcnt(4)
    v_mfma_f32_16x16x32_bf16 v[40:43], v[32:35], v[72:75], v[40:43]
    v_mfma_f32_16x16x32_bf16 v[44:47], v[32:35], v[96:99], v[44:47]
    v_mfma_f32_16x16x32_bf16 v[52:55], v[36:39], v[72:75], v[52:55]
    v_mfma_f32_16x16x32_bf16 v[56:59], v[36:39], v[96:99], v[56:59]
    ds_read_b128 v[32:35], v12 offset:8192
    ds_read_b128 v[36:39], v12 offset:10240
    s_add_u32 m0, s36, 3968
    s_nop 0
    buffer_load_dwordx4 v3, s[12:15], s41 offen offset:128 nt lds
    s_waitcnt lgkmcnt(4)
    v_mfma_f32_16x16x32_bf16 v[40:43], v[16:19], v[76:79], v[40:43]
    v_mfma_f32_16x16x32_bf16 v[44:47], v[16:19], v[100:103], v[44:47]
    v_mfma_f32_16x16x32_bf16 v[52:55], v[20:23], v[76:79], v[52:55]
    v_mfma_f32_16x16x32_bf16 v[56:59], v[20:23], v[100:103], v[56:59]
    s_waitcnt lgkmcnt(2)
    v_mfma_f32_16x16x32_bf16 v[40:43], v[24:27], v[80:83], v[40:43]
    v_mfma_f32_16x16x32_bf16 v[44:47], v[24:27], v[104:107], v[44:47]
    v_mfma_f32_16x16x32_bf16 v[52:55], v[28:31], v[80:83], v[52:55]
    v_mfma_f32_16x16x32_bf16 v[56:59], v[28:31], v[104:107], v[56:59]
    s_add_u32 m0, s36, 7936
    s_nop 0
    buffer_load_dwordx4 v3, s[12:15], s41 offen offset:256 nt lds
    s_waitcnt lgkmcnt(0)
    v_mfma_f32_16x16x32_bf16 v[40:43], v[32:35], v[84:87], v[40:43]
    v_mfma_f32_16x16x32_bf16 v[44:47], v[32:35], v[108:111], v[44:47]
    v_mfma_f32_16x16x32_bf16 v[52:55], v[36:39], v[84:87], v[52:55]
    v_mfma_f32_16x16x32_bf16 v[56:59], v[36:39], v[108:111], v[56:59]
    s_add_u32 s36, s35, s25
    s_add_u32 s35, s35, 12288
    s_cmp_eq_u32 s35, 73728
    s_cselect_b32 s35, 0, s35
    s_nop 0
    v_max3_f32 v16, v40, v41, v42
    s_nop 0
    v_max3_f32 v16, v16, v43, v52
    v_max3_f32 v16, v16, v53, v54
    v_max_f32 v16, v16, v55
    v_fma_f32 v19, v16, s38, -v5
    v_max3_f32 v17, v44, v45, v46
    v_max3_f32 v17, v17, v47, v56
    v_max3_f32 v17, v17, v57, v58
    v_max_f32 v17, v17, v59
    v_fma_f32 v20, v17, s38, -v6
    v_max_f32 v19, v19, v20
    v_cmp_lt_f32 vcc, s39, v19
    s_cbranch_vccnz attn_kernel_l_rare
attn_kernel_l_back:
    v_fma_f32 v40, v40, s38, -v5
    v_fma_f32 v41, v41, s38, -v5
    v_fma_f32 v42, v42, s38, -v5
    v_fma_f32 v43, v43, s38, -v5
    v_fma_f32 v52, v52, s38, -v5
    v_fma_f32 v53, v53, s38, -v5
    v_fma_f32 v54, v54, s38, -v5
    v_fma_f32 v55, v55, s38, -v5
    v_exp_f32 v40, v40
    v_exp_f32 v41, v41
    v_exp_f32 v42, v42
    v_exp_f32 v43, v43
    v_exp_f32 v52, v52
    v_exp_f32 v53, v53
    v_exp_f32 v54, v54
    v_exp_f32 v55, v55
    v_add_f32 v24, v40, v41
    v_add_f32 v25, v42, v43
    v_add_f32 v26, v52, v53
    v_add_f32 v27, v54, v55
    v_add_f32 v24, v24, v25
    v_add_f32 v26, v26, v27
    v_add_f32 v8, v8, v24
    v_add_f32 v8, v8, v26
    v_cvt_pk_bf16_f32 v40, v40, v41
    v_cvt_pk_bf16_f32 v41, v42, v43
    v_cvt_pk_bf16_f32 v42, v52, v53
    v_cvt_pk_bf16_f32 v43, v54, v55
    v_fma_f32 v44, v44, s38, -v6
    v_fma_f32 v45, v45, s38, -v6
    v_fma_f32 v46, v46, s38, -v6
    v_fma_f32 v47, v47, s38, -v6
    v_fma_f32 v56, v56, s38, -v6
    v_fma_f32 v57, v57, s38, -v6
    v_fma_f32 v58, v58, s38, -v6
    v_fma_f32 v59, v59, s38, -v6
    v_exp_f32 v44, v44
    v_exp_f32 v45, v45
    v_exp_f32 v46, v46
    v_exp_f32 v47, v47
    v_exp_f32 v56, v56
    v_exp_f32 v57, v57
    v_exp_f32 v58, v58
    v_exp_f32 v59, v59
    v_add_f32 v24, v44, v45
    v_add_f32 v25, v46, v47
    v_add_f32 v26, v56, v57
    v_add_f32 v27, v58, v59
    v_add_f32 v24, v24, v25
    v_add_f32 v26, v26, v27
    v_add_f32 v9, v9, v24
    v_add_f32 v9, v9, v26
    v_cvt_pk_bf16_f32 v44, v44, v45
    v_cvt_pk_bf16_f32 v45, v46, v47
    v_cvt_pk_bf16_f32 v46, v56, v57
    v_cvt_pk_bf16_f32 v47, v58, v59
    s_waitcnt vmcnt(12)
    s_barrier
    s_cmp_lt_u32 s30, s31
    s_cselect_b32 s41, s30, s34
    s_add_u32 s30, s30, 12288
    v_add_u32 v11, s35, v1
    v_xor_b32 v12, 32, v11
    v_xor_b32 v13, 64, v11
    v_xor_b32 v14, 96, v11
    ds_read_b64_tr_b16 v[16:17], v11
    ds_read_b64_tr_b16 v[18:19], v11 offset:2048
    ds_read_b64_tr_b16 v[20:21], v12
    ds_read_b64_tr_b16 v[22:23], v12 offset:2048
    ds_read_b64_tr_b16 v[24:25], v13
    ds_read_b64_tr_b16 v[26:27], v13 offset:2048
    ds_read_b64_tr_b16 v[28:29], v14
    ds_read_b64_tr_b16 v[30:31], v14 offset:2048
    ds_read_b64_tr_b16 v[32:33], v11 offset:4096
    ds_read_b64_tr_b16 v[34:35], v11 offset:6144
    s_waitcnt lgkmcnt(8)
    v_mfma_f32_16x16x32_bf16 v[112:115], v[16:19], v[40:43], v[112:115]
    v_mfma_f32_16x16x32_bf16 v[116:119], v[16:19], v[44:47], v[116:119]
    ds_read_b64_tr_b16 v[36:37], v12 offset:4096
    ds_read_b64_tr_b16 v[38:39], v12 offset:6144
    s_waitcnt lgkmcnt(8)
    v_mfma_f32_16x16x32_bf16 v[124:127], v[20:23], v[40:43], v[124:127]
    v_mfma_f32_16x16x32_bf16 v[128:131], v[20:23], v[44:47], v[128:131]
    s_add_u32 m0, s36, 0
    s_nop 0
    buffer_load_dwordx4 v2, s[8:11], s41 offen nt lds
    ds_read_b64_tr_b16 v[16:17], v13 offset:4096
    ds_read_b64_tr_b16 v[18:19], v13 offset:6144
    s_waitcnt lgkmcnt(8)
    v_mfma_f32_16x16x32_bf16 v[136:139], v[24:27], v[40:43], v[136:139]
    v_mfma_f32_16x16x32_bf16 v[140:143], v[24:27], v[44:47], v[140:143]
    ds_read_b64_tr_b16 v[20:21], v14 offset:4096
    ds_read_b64_tr_b16 v[22:23], v14 offset:6144
    s_waitcnt lgkmcnt(8)
    v_mfma_f32_16x16x32_bf16 v[148:151], v[28:31], v[40:43], v[148:151]
    v_mfma_f32_16x16x32_bf16 v[152:155], v[28:31], v[44:47], v[152:155]
    ds_read_b64_tr_b16 v[24:25], v11 offset:8192
    ds_read_b64_tr_b16 v[26:27], v11 offset:10240
    s_waitcnt lgkmcnt(8)
    v_mfma_f32_16x16x32_bf16 v[160:163], v[32:35], v[40:43], v[160:163]
    v_mfma_f32_16x16x32_bf16 v[164:167], v[32:35], v[44:47], v[164:167]
    s_add_u32 m0, s36, 3968
    s_nop 0
    buffer_load_dwordx4 v2, s[8:11], s41 offen offset:128 nt lds
    ds_read_b64_tr_b16 v[28:29], v12 offset:8192
    ds_read_b64_tr_b16 v[30:31], v12 offset:10240
    s_waitcnt lgkmcnt(8)
    v_mfma_f32_16x16x32_bf16 v[172:175], v[36:39], v[40:43], v[172:175]
    v_mfma_f32_16x16x32_bf16 v[176:179], v[36:39], v[44:47], v[176:179]
    ds_read_b64_tr_b16 v[32:33], v13 offset:8192
    ds_read_b64_tr_b16 v[34:35], v13 offset:10240
    s_waitcnt lgkmcnt(8)
    v_mfma_f32_16x16x32_bf16 v[184:187], v[16:19], v[40:43], v[184:187]
    v_mfma_f32_16x16x32_bf16 v[188:191], v[16:19], v[44:47], v[188:191]
    ds_read_b64_tr_b16 v[36:37], v14 offset:8192
    ds_read_b64_tr_b16 v[38:39], v14 offset:10240
    s_waitcnt lgkmcnt(8)
    v_mfma_f32_16x16x32_bf16 v[196:199], v[20:23], v[40:43], v[196:199]
    v_mfma_f32_16x16x32_bf16 v[200:203], v[20:23], v[44:47], v[200:203]
    s_add_u32 m0, s36, 7936
    s_nop 0
    buffer_load_dwordx4 v2, s[8:11], s41 offen offset:256 nt lds
    s_waitcnt lgkmcnt(6)
    v_mfma_f32_16x16x32_bf16 v[208:211], v[24:27], v[40:43], v[208:211]
    v_mfma_f32_16x16x32_bf16 v[212:215], v[24:27], v[44:47], v[212:215]
    s_waitcnt lgkmcnt(4)
    v_mfma_f32_16x16x32_bf16 v[220:223], v[28:31], v[40:43], v[220:223]
    v_mfma_f32_16x16x32_bf16 v[224:227], v[28:31], v[44:47], v[224:227]
    s_waitcnt lgkmcnt(2)
    v_mfma_f32_16x16x32_bf16 v[232:235], v[32:35], v[40:43], v[232:235]
    v_mfma_f32_16x16x32_bf16 v[236:239], v[32:35], v[44:47], v[236:239]
    s_waitcnt lgkmcnt(0)
    v_mfma_f32_16x16x32_bf16 v[244:247], v[36:39], v[40:43], v[244:247]
    v_mfma_f32_16x16x32_bf16 v[248:251], v[36:39], v[44:47], v[248:251]
    s_add_u32 s36, s35, s25
    s_add_u32 s35, s35, 12288
    s_cmp_eq_u32 s35, 73728
    s_cselect_b32 s35, 0, s35
    s_add_u32 s37, s37, 1
    s_cmp_lt_u32 s37, 16
    s_cbranch_scc1 attn_kernel_l_loop
    v_mbcnt_lo_u32_b32 v12, -1, 0
    v_mbcnt_hi_u32_b32 v12, -1, v12
    v_and_b32 v11, 15, v12
    v_add_u32 v11, s57, v11
    v_lshlrev_b32 v11, 7, v11
    v_lshrrev_b32 v12, 4, v12
    v_lshl_add_u32 v11, v12, 4, v11
    v_add_u32 v12, 4096, v11
    v_mov_b32 v16, v8
    s_nop 1
    v_permlane32_swap_b32 v8, v16
    v_add_f32 v8, v8, v16
    v_mov_b32 v16, v8
    s_nop 1
    v_permlane16_swap_b32 v8, v16
    v_add_f32 v8, v8, v16
    v_rcp_f32 v8, v8
    v_mov_b32 v16, v9
    s_nop 1
    v_permlane32_swap_b32 v9, v16
    v_add_f32 v9, v9, v16
    v_mov_b32 v16, v9
    s_nop 1
    v_permlane16_swap_b32 v9, v16
    v_add_f32 v9, v9, v16
    v_rcp_f32 v9, v9
    v_mul_f32 v112, v112, v8
    v_mul_f32 v113, v113, v8
    v_mul_f32 v114, v114, v8
    v_mul_f32 v115, v115, v8
    v_mul_f32 v124, v124, v8
    v_mul_f32 v125, v125, v8
    v_mul_f32 v126, v126, v8
    v_mul_f32 v127, v127, v8
    v_cvt_pk_bf16_f32 v16, v112, v113
    v_cvt_pk_bf16_f32 v17, v114, v115
    v_cvt_pk_bf16_f32 v18, v124, v125
    v_cvt_pk_bf16_f32 v19, v126, v127
    s_nop 0
    v_permlane32_swap_b32 v16, v18
    v_permlane32_swap_b32 v17, v19
    s_nop 0
    v_permlane16_swap_b32 v16, v18
    v_permlane16_swap_b32 v17, v19
    buffer_store_dwordx4 v[16:19], v11, s[20:23], s54 offen
    v_mul_f32 v136, v136, v8
    v_mul_f32 v137, v137, v8
    v_mul_f32 v138, v138, v8
    v_mul_f32 v139, v139, v8
    v_mul_f32 v148, v148, v8
    v_mul_f32 v149, v149, v8
    v_mul_f32 v150, v150, v8
    v_mul_f32 v151, v151, v8
    v_cvt_pk_bf16_f32 v20, v136, v137
    v_cvt_pk_bf16_f32 v21, v138, v139
    v_cvt_pk_bf16_f32 v22, v148, v149
    v_cvt_pk_bf16_f32 v23, v150, v151
    s_nop 0
    v_permlane32_swap_b32 v20, v22
    v_permlane32_swap_b32 v21, v23
    s_nop 0
    v_permlane16_swap_b32 v20, v22
    v_permlane16_swap_b32 v21, v23
    buffer_store_dwordx4 v[20:23], v11, s[20:23], s54 offen offset:64
    v_mul_f32 v160, v160, v8
    v_mul_f32 v161, v161, v8
    v_mul_f32 v162, v162, v8
    v_mul_f32 v163, v163, v8
    v_mul_f32 v172, v172, v8
    v_mul_f32 v173, v173, v8
    v_mul_f32 v174, v174, v8
    v_mul_f32 v175, v175, v8
    v_cvt_pk_bf16_f32 v24, v160, v161
    v_cvt_pk_bf16_f32 v25, v162, v163
    v_cvt_pk_bf16_f32 v26, v172, v173
    v_cvt_pk_bf16_f32 v27, v174, v175
    s_nop 0
    v_permlane32_swap_b32 v24, v26
    v_permlane32_swap_b32 v25, v27
    s_nop 0
    v_permlane16_swap_b32 v24, v26
    v_permlane16_swap_b32 v25, v27
    buffer_store_dwordx4 v[24:27], v11, s[20:23], s55 offen
    v_mul_f32 v184, v184, v8
    v_mul_f32 v185, v185, v8
    v_mul_f32 v186, v186, v8
    v_mul_f32 v187, v187, v8
    v_mul_f32 v196, v196, v8
    v_mul_f32 v197, v197, v8
    v_mul_f32 v198, v198, v8
    v_mul_f32 v199, v199, v8
    v_cvt_pk_bf16_f32 v28, v184, v185
    v_cvt_pk_bf16_f32 v29, v186, v187
    v_cvt_pk_bf16_f32 v30, v196, v197
    v_cvt_pk_bf16_f32 v31, v198, v199
    s_nop 0
    v_permlane32_swap_b32 v28, v30
    v_permlane32_swap_b32 v29, v31
    s_nop 0
    v_permlane16_swap_b32 v28, v30
    v_permlane16_swap_b32 v29, v31
    buffer_store_dwordx4 v[28:31], v11, s[20:23], s55 offen offset:64
    v_mul_f32 v208, v208, v8
    v_mul_f32 v209, v209, v8
    v_mul_f32 v210, v210, v8
    v_mul_f32 v211, v211, v8
    v_mul_f32 v220, v220, v8
    v_mul_f32 v221, v221, v8
    v_mul_f32 v222, v222, v8
    v_mul_f32 v223, v223, v8
    v_cvt_pk_bf16_f32 v32, v208, v209
    v_cvt_pk_bf16_f32 v33, v210, v211
    v_cvt_pk_bf16_f32 v34, v220, v221
    v_cvt_pk_bf16_f32 v35, v222, v223
    s_nop 0
    v_permlane32_swap_b32 v32, v34
    v_permlane32_swap_b32 v33, v35
    s_nop 0
    v_permlane16_swap_b32 v32, v34
    v_permlane16_swap_b32 v33, v35
    buffer_store_dwordx4 v[32:35], v11, s[20:23], s56 offen
    v_mul_f32 v232, v232, v8
    v_mul_f32 v233, v233, v8
    v_mul_f32 v234, v234, v8
    v_mul_f32 v235, v235, v8
    v_mul_f32 v244, v244, v8
    v_mul_f32 v245, v245, v8
    v_mul_f32 v246, v246, v8
    v_mul_f32 v247, v247, v8
    v_cvt_pk_bf16_f32 v36, v232, v233
    v_cvt_pk_bf16_f32 v37, v234, v235
    v_cvt_pk_bf16_f32 v38, v244, v245
    v_cvt_pk_bf16_f32 v39, v246, v247
    s_nop 0
    v_permlane32_swap_b32 v36, v38
    v_permlane32_swap_b32 v37, v39
    s_nop 0
    v_permlane16_swap_b32 v36, v38
    v_permlane16_swap_b32 v37, v39
    buffer_store_dwordx4 v[36:39], v11, s[20:23], s56 offen offset:64
    v_mul_f32 v116, v116, v9
    v_mul_f32 v117, v117, v9
    v_mul_f32 v118, v118, v9
    v_mul_f32 v119, v119, v9
    v_mul_f32 v128, v128, v9
    v_mul_f32 v129, v129, v9
    v_mul_f32 v130, v130, v9
    v_mul_f32 v131, v131, v9
    v_cvt_pk_bf16_f32 v16, v116, v117
    v_cvt_pk_bf16_f32 v17, v118, v119
    v_cvt_pk_bf16_f32 v18, v128, v129
    v_cvt_pk_bf16_f32 v19, v130, v131
    s_nop 0
    v_permlane32_swap_b32 v16, v18
    v_permlane32_swap_b32 v17, v19
    s_nop 0
    v_permlane16_swap_b32 v16, v18
    v_permlane16_swap_b32 v17, v19
    buffer_store_dwordx4 v[16:19], v11, s[20:23], s54 offen offset:2048
    v_mul_f32 v140, v140, v9
    v_mul_f32 v141, v141, v9
    v_mul_f32 v142, v142, v9
    v_mul_f32 v143, v143, v9
    v_mul_f32 v152, v152, v9
    v_mul_f32 v153, v153, v9
    v_mul_f32 v154, v154, v9
    v_mul_f32 v155, v155, v9
    v_cvt_pk_bf16_f32 v20, v140, v141
    v_cvt_pk_bf16_f32 v21, v142, v143
    v_cvt_pk_bf16_f32 v22, v152, v153
    v_cvt_pk_bf16_f32 v23, v154, v155
    s_nop 0
    v_permlane32_swap_b32 v20, v22
    v_permlane32_swap_b32 v21, v23
    s_nop 0
    v_permlane16_swap_b32 v20, v22
    v_permlane16_swap_b32 v21, v23
    buffer_store_dwordx4 v[20:23], v11, s[20:23], s54 offen offset:2112
    v_mul_f32 v164, v164, v9
    v_mul_f32 v165, v165, v9
    v_mul_f32 v166, v166, v9
    v_mul_f32 v167, v167, v9
    v_mul_f32 v176, v176, v9
    v_mul_f32 v177, v177, v9
    v_mul_f32 v178, v178, v9
    v_mul_f32 v179, v179, v9
    v_cvt_pk_bf16_f32 v24, v164, v165
    v_cvt_pk_bf16_f32 v25, v166, v167
    v_cvt_pk_bf16_f32 v26, v176, v177
    v_cvt_pk_bf16_f32 v27, v178, v179
    s_nop 0
    v_permlane32_swap_b32 v24, v26
    v_permlane32_swap_b32 v25, v27
    s_nop 0
    v_permlane16_swap_b32 v24, v26
    v_permlane16_swap_b32 v25, v27
    buffer_store_dwordx4 v[24:27], v11, s[20:23], s55 offen offset:2048
    v_mul_f32 v188, v188, v9
    v_mul_f32 v189, v189, v9
    v_mul_f32 v190, v190, v9
    v_mul_f32 v191, v191, v9
    v_mul_f32 v200, v200, v9
    v_mul_f32 v201, v201, v9
    v_mul_f32 v202, v202, v9
    v_mul_f32 v203, v203, v9
    v_cvt_pk_bf16_f32 v28, v188, v189
    v_cvt_pk_bf16_f32 v29, v190, v191
    v_cvt_pk_bf16_f32 v30, v200, v201
    v_cvt_pk_bf16_f32 v31, v202, v203
    s_nop 0
    v_permlane32_swap_b32 v28, v30
    v_permlane32_swap_b32 v29, v31
    s_nop 0
    v_permlane16_swap_b32 v28, v30
    v_permlane16_swap_b32 v29, v31
    buffer_store_dwordx4 v[28:31], v11, s[20:23], s55 offen offset:2112
    v_mul_f32 v212, v212, v9
    v_mul_f32 v213, v213, v9
    v_mul_f32 v214, v214, v9
    v_mul_f32 v215, v215, v9
    v_mul_f32 v224, v224, v9
    v_mul_f32 v225, v225, v9
    v_mul_f32 v226, v226, v9
    v_mul_f32 v227, v227, v9
    v_cvt_pk_bf16_f32 v32, v212, v213
    v_cvt_pk_bf16_f32 v33, v214, v215
    v_cvt_pk_bf16_f32 v34, v224, v225
    v_cvt_pk_bf16_f32 v35, v226, v227
    s_nop 0
    v_permlane32_swap_b32 v32, v34
    v_permlane32_swap_b32 v33, v35
    s_nop 0
    v_permlane16_swap_b32 v32, v34
    v_permlane16_swap_b32 v33, v35
    buffer_store_dwordx4 v[32:35], v11, s[20:23], s56 offen offset:2048
    v_mul_f32 v236, v236, v9
    v_mul_f32 v237, v237, v9
    v_mul_f32 v238, v238, v9
    v_mul_f32 v239, v239, v9
    v_mul_f32 v248, v248, v9
    v_mul_f32 v249, v249, v9
    v_mul_f32 v250, v250, v9
    v_mul_f32 v251, v251, v9
    v_cvt_pk_bf16_f32 v36, v236, v237
    v_cvt_pk_bf16_f32 v37, v238, v239
    v_cvt_pk_bf16_f32 v38, v248, v249
    v_cvt_pk_bf16_f32 v39, v250, v251
    s_nop 0
    v_permlane32_swap_b32 v36, v38
    v_permlane32_swap_b32 v37, v39
    s_nop 0
    v_permlane16_swap_b32 v36, v38
    v_permlane16_swap_b32 v37, v39
    buffer_store_dwordx4 v[36:39], v11, s[20:23], s56 offen offset:2112
    s_endpgm
attn_kernel_l_rare:
    s_nop 1
    v_mov_b32 v24, v16
    s_nop 1
    v_permlane32_swap_b32 v16, v24
    v_max_f32 v16, v16, v24
    v_mov_b32 v24, v16
    s_nop 1
    v_permlane16_swap_b32 v16, v24
    v_max_f32 v16, v16, v24
    v_mul_f32 v16, s38, v16
    v_max_f32 v16, v16, v5
    v_sub_f32 v24, v5, v16
    v_exp_f32 v24, v24
    v_mov_b32 v5, v16
    v_mul_f32 v8, v8, v24
    v_mul_f32 v112, v112, v24
    v_mul_f32 v113, v113, v24
    v_mul_f32 v114, v114, v24
    v_mul_f32 v115, v115, v24
    v_mul_f32 v124, v124, v24
    v_mul_f32 v125, v125, v24
    v_mul_f32 v126, v126, v24
    v_mul_f32 v127, v127, v24
    v_mul_f32 v136, v136, v24
    v_mul_f32 v137, v137, v24
    v_mul_f32 v138, v138, v24
    v_mul_f32 v139, v139, v24
    v_mul_f32 v148, v148, v24
    v_mul_f32 v149, v149, v24
    v_mul_f32 v150, v150, v24
    v_mul_f32 v151, v151, v24
    v_mul_f32 v160, v160, v24
    v_mul_f32 v161, v161, v24
    v_mul_f32 v162, v162, v24
    v_mul_f32 v163, v163, v24
    v_mul_f32 v172, v172, v24
    v_mul_f32 v173, v173, v24
    v_mul_f32 v174, v174, v24
    v_mul_f32 v175, v175, v24
    v_mul_f32 v184, v184, v24
    v_mul_f32 v185, v185, v24
    v_mul_f32 v186, v186, v24
    v_mul_f32 v187, v187, v24
    v_mul_f32 v196, v196, v24
    v_mul_f32 v197, v197, v24
    v_mul_f32 v198, v198, v24
    v_mul_f32 v199, v199, v24
    v_mul_f32 v208, v208, v24
    v_mul_f32 v209, v209, v24
    v_mul_f32 v210, v210, v24
    v_mul_f32 v211, v211, v24
    v_mul_f32 v220, v220, v24
    v_mul_f32 v221, v221, v24
    v_mul_f32 v222, v222, v24
    v_mul_f32 v223, v223, v24
    v_mul_f32 v232, v232, v24
    v_mul_f32 v233, v233, v24
    v_mul_f32 v234, v234, v24
    v_mul_f32 v235, v235, v24
    v_mul_f32 v244, v244, v24
    v_mul_f32 v245, v245, v24
    v_mul_f32 v246, v246, v24
    v_mul_f32 v247, v247, v24
    v_mov_b32 v24, v17
    s_nop 1
    v_permlane32_swap_b32 v17, v24
    v_max_f32 v17, v17, v24
    v_mov_b32 v24, v17
    s_nop 1
    v_permlane16_swap_b32 v17, v24
    v_max_f32 v17, v17, v24
    v_mul_f32 v17, s38, v17
    v_max_f32 v17, v17, v6
    v_sub_f32 v24, v6, v17
    v_exp_f32 v24, v24
    v_mov_b32 v6, v17
    v_mul_f32 v9, v9, v24
    v_mul_f32 v116, v116, v24
    v_mul_f32 v117, v117, v24
    v_mul_f32 v118, v118, v24
    v_mul_f32 v119, v119, v24
    v_mul_f32 v128, v128, v24
    v_mul_f32 v129, v129, v24
    v_mul_f32 v130, v130, v24
    v_mul_f32 v131, v131, v24
    v_mul_f32 v140, v140, v24
    v_mul_f32 v141, v141, v24
    v_mul_f32 v142, v142, v24
    v_mul_f32 v143, v143, v24
    v_mul_f32 v152, v152, v24
    v_mul_f32 v153, v153, v24
    v_mul_f32 v154, v154, v24
    v_mul_f32 v155, v155, v24
    v_mul_f32 v164, v164, v24
    v_mul_f32 v165, v165, v24
    v_mul_f32 v166, v166, v24
    v_mul_f32 v167, v167, v24
    v_mul_f32 v176, v176, v24
    v_mul_f32 v177, v177, v24
    v_mul_f32 v178, v178, v24
    v_mul_f32 v179, v179, v24
    v_mul_f32 v188, v188, v24
    v_mul_f32 v189, v189, v24
    v_mul_f32 v190, v190, v24
    v_mul_f32 v191, v191, v24
    v_mul_f32 v200, v200, v24
    v_mul_f32 v201, v201, v24
    v_mul_f32 v202, v202, v24
    v_mul_f32 v203, v203, v24
    v_mul_f32 v212, v212, v24
    v_mul_f32 v213, v213, v24
    v_mul_f32 v214, v214, v24
    v_mul_f32 v215, v215, v24
    v_mul_f32 v224, v224, v24
    v_mul_f32 v225, v225, v24
    v_mul_f32 v226, v226, v24
    v_mul_f32 v227, v227, v24
    v_mul_f32 v236, v236, v24
    v_mul_f32 v237, v237, v24
    v_mul_f32 v238, v238, v24
    v_mul_f32 v239, v239, v24
    v_mul_f32 v248, v248, v24
    v_mul_f32 v249, v249, v24
    v_mul_f32 v250, v250, v24
    v_mul_f32 v251, v251, v24
    s_nop 1
    s_branch attn_kernel_l_back
attn_kernel_exit:
    s_endpgm
.globl oproj_kernel
.p2align 8
.type oproj_kernel,@function
oproj_kernel:
    s_cmp_ge_u32 s2, 240
    s_cbranch_scc1 oproj_kernel_exit
    s_and_b32 s26, s2, 7
    s_lshr_b32 s27, s2, 3
    s_lshr_b32 s30, s26, 2
    s_mul_i32 s32, s27, 43
    s_lshr_b32 s32, s32, 8
    s_mul_i32 s28, s32, 6
    s_sub_u32 s27, s27, s28
    s_and_b32 s26, s26, 3
    s_mul_i32 s31, s26, 6
    s_add_u32 s31, s31, s27
    s_mul_i32 s29, s30, 40
    s_add_u32 s26, s0, s29
    s_addc_u32 s27, s1, 0
    s_load_dwordx2 s[36:37], s[26:27], 32
    s_load_dwordx2 s[38:39], s[0:1], 96
    s_load_dwordx2 s[40:41], s[0:1], 80
    v_lshrrev_b32 v6, 6, v0
    s_nop 0
    v_readfirstlane_b32 s16, v6
    v_and_b32 v7, 63, v0
    s_lshl_b32 s17, s16, 10
    v_and_b32 v8, 15, v7
    v_lshrrev_b32 v9, 4, v7
    v_bfe_u32 v10, v7, 2, 2
    v_and_b32 v11, 3, v7
    v_and_b32 v12, 1, v9
    v_lshl_or_b32 v12, v12, 2, v10
    v_lshlrev_b32 v12, 1, v12
    v_lshrrev_b32 v13, 1, v11
    s_and_b32 s28, s16, 1
    s_lshl_b32 s29, s28, 3
    v_add_u32 v13, s29, v13
    v_xor_b32 v12, v12, v13
    v_lshlrev_b32 v12, 4, v12
    v_and_b32 v13, 1, v11
    v_lshl_add_u32 v12, v13, 3, v12
    v_lshl_add_u32 v13, v9, 3, v10
    v_lshl_add_u32 v1, v13, 8, v12
    s_lshr_b32 s27, s16, 1
    s_mul_i32 s27, s27, 48
    v_lshrrev_b32 v12, 1, v8
    v_xor_b32 v12, v9, v12
    v_lshlrev_b32 v12, 4, v12
    v_add_u32 v13, s27, v8
    v_lshl_add_u32 v3, v13, 7, v12
    v_add_u32 v3, 16384, v3
    s_mul_i32 s26, s31, 96
    s_add_u32 s42, s26, s27
    s_lshl_b32 s29, s28, 2
    v_add_u32 v12, s29, v9
    v_and_b32 v13, 7, v7
    v_xor_b32 v12, v12, v13
    v_lshlrev_b32 v12, 4, v12
    v_lshrrev_b32 v13, 3, v7
    v_lshl_add_u32 v12, v13, 7, v12
    v_add_u32 v2, s17, v12
    v_lshrrev_b32 v12, 4, v7
    s_lshl_b32 s29, s16, 2
    v_add_u32 v12, s29, v12
    v_and_b32 v13, 3, v12
    v_bfe_u32 v14, v12, 3, 1
    v_lshl_or_b32 v13, v14, 2, v13
    v_lshlrev_b32 v13, 1, v13
    v_xor_b32 v13, v13, v8
    v_lshlrev_b32 v13, 4, v13
    v_mul_u32_u24 v12, 1280, v12
    v_add_u32 v0, v12, v13
    s_mov_b32 s22, 1073741824
    s_lshl_b32 s18, s32, 8
    s_add_u32 s19, s18, 7864320
    s_mul_i32 s20, s30, 28311552
    s_lshl_b32 s26, s26, 7
    s_add_u32 s20, s20, s26
    s_waitcnt lgkmcnt(0)
    s_mov_b32 s4, s38
    s_and_b32 s5, s39, 65535
    s_mov_b32 s6, 56623104
    s_mov_b32 s7, 131072
    s_mov_b32 s8, s36
    s_and_b32 s9, s37, 65535
    s_mov_b32 s10, 7864320
    s_mov_b32 s11, 131072
    s_mov_b32 s12, s40
    s_and_b32 s13, s41, 65535
    s_mov_b32 s14, 5898240
    s_mov_b32 s15, 131072
    v_mov_b32 v48, 0
    v_mov_b32 v49, 0
    v_mov_b32 v50, 0
    v_mov_b32 v51, 0
    v_mov_b32 v52, 0
    v_mov_b32 v53, 0
    v_mov_b32 v54, 0
    v_mov_b32 v55, 0
    v_mov_b32 v56, 0
    v_mov_b32 v57, 0
    v_mov_b32 v58, 0
    v_mov_b32 v59, 0
    v_mov_b32 v60, 0
    v_mov_b32 v61, 0
    v_mov_b32 v62, 0
    v_mov_b32 v63, 0
    v_mov_b32 v64, 0
    v_mov_b32 v65, 0
    v_mov_b32 v66, 0
    v_mov_b32 v67, 0
    v_mov_b32 v68, 0
    v_mov_b32 v69, 0
    v_mov_b32 v70, 0
    v_mov_b32 v71, 0
    v_mov_b32 v72, 0
    v_mov_b32 v73, 0
    v_mov_b32 v74, 0
    v_mov_b32 v75, 0
    v_mov_b32 v76, 0
    v_mov_b32 v77, 0
    v_mov_b32 v78, 0
    v_mov_b32 v79, 0
    v_mov_b32 v80, 0
    v_mov_b32 v81, 0
    v_mov_b32 v82, 0
    v_mov_b32 v83, 0
    v_mov_b32 v84, 0
    v_mov_b32 v85, 0
    v_mov_b32 v86, 0
    v_mov_b32 v87, 0
    v_mov_b32 v88, 0
    v_mov_b32 v89, 0
    v_mov_b32 v90, 0
    v_mov_b32 v91, 0
    v_mov_b32 v92, 0
    v_mov_b32 v93, 0
    v_mov_b32 v94, 0
    v_mov_b32 v95, 0
    s_add_u32 s26, s17, 0
    s_cmp_lt_u32 s18, s19
    s_cselect_b32 s27, s18, s22
    s_cselect_b32 s28, s20, s22
    s_add_u32 m0, s26, 0
    s_nop 0
    buffer_load_dwordx4 v0, s[8:11], s27 offen lds
    s_add_u32 s27, s27, 20480
    s_add_u32 m0, s26, 4096
    s_nop 0
    buffer_load_dwordx4 v0, s[8:11], s27 offen lds
    s_add_u32 s27, s27, 20480
    s_add_u32 m0, s26, 8192
    s_nop 0
    buffer_load_dwordx4 v0, s[8:11], s27 offen lds
    s_add_u32 s27, s27, 20480
    s_add_u32 m0, s26, 12288
    s_nop 0
    buffer_load_dwordx4 v0, s[8:11], s27 offen lds
    s_add_u32 m0, s26, 16384
    s_nop 0
    buffer_load_dwordx4 v2, s[4:7], s28 offen lds
    s_add_u32 s28, s28, 4096
    s_add_u32 m0, s26, 20480
    s_nop 0
    buffer_load_dwordx4 v2, s[4:7], s28 offen lds
    s_add_u32 s28, s28, 4096
    s_add_u32 m0, s26, 24576
    s_nop 0
    buffer_load_dwordx4 v2, s[4:7], s28 offen lds
    s_add_u32 s18, s18, 81920
    s_add_u32 s20, s20, 294912
    s_add_u32 s26, s17, 28672
    s_cmp_lt_u32 s18, s19
    s_cselect_b32 s27, s18, s22
    s_cselect_b32 s28, s20, s22
    s_add_u32 m0, s26, 0
    s_nop 0
    buffer_load_dwordx4 v0, s[8:11], s27 offen lds
    s_add_u32 s27, s27, 20480
    s_add_u32 m0, s26, 4096
    s_nop 0
    buffer_load_dwordx4 v0, s[8:11], s27 offen lds
    s_add_u32 s27, s27, 20480
    s_add_u32 m0, s26, 8192
    s_nop 0
    buffer_load_dwordx4 v0, s[8:11], s27 offen lds
    s_add_u32 s27, s27, 20480
    s_add_u32 m0, s26, 12288
    s_nop 0
    buffer_load_dwordx4 v0, s[8:11], s27 offen lds
    s_add_u32 m0, s26, 16384
    s_nop 0
    buffer_load_dwordx4 v2, s[4:7], s28 offen lds
    s_add_u32 s28, s28, 4096
    s_add_u32 m0, s26, 20480
    s_nop 0
    buffer_load_dwordx4 v2, s[4:7], s28 offen lds
    s_add_u32 s28, s28, 4096
    s_add_u32 m0, s26, 24576
    s_nop 0
    buffer_load_dwordx4 v2, s[4:7], s28 offen lds
    s_add_u32 s18, s18, 81920
    s_add_u32 s20, s20, 294912
    s_add_u32 s26, s17, 57344
    s_cmp_lt_u32 s18, s19
    s_cselect_b32 s27, s18, s22
    s_cselect_b32 s28, s20, s22
    s_add_u32 m0, s26, 0
    s_nop 0
    buffer_load_dwordx4 v0, s[8:11], s27 offen lds
    s_add_u32 s27, s27, 20480
    s_add_u32 m0, s26, 4096
    s_nop 0
    buffer_load_dwordx4 v0, s[8:11], s27 offen lds
    s_add_u32 s27, s27, 20480
    s_add_u32 m0, s26, 8192
    s_nop 0
    buffer_load_dwordx4 v0, s[8:11], s27 offen lds
    s_add_u32 s27, s27, 20480
    s_add_u32 m0, s26, 12288
    s_nop 0
    buffer_load_dwordx4 v0, s[8:11], s27 offen lds
    s_add_u32 m0, s26, 16384
    s_nop 0
    buffer_load_dwordx4 v2, s[4:7], s28 offen lds
    s_add_u32 s28, s28, 4096
    s_add_u32 m0, s26, 20480
    s_nop 0
    buffer_load_dwordx4 v2, s[4:7], s28 offen lds
    s_add_u32 s28, s28, 4096
    s_add_u32 m0, s26, 24576
    s_nop 0
    buffer_load_dwordx4 v2, s[4:7], s28 offen lds
    s_add_u32 s18, s18, 81920
    s_add_u32 s20, s20, 294912
    s_add_u32 s26, s17, 86016
    s_cmp_lt_u32 s18, s19
    s_cselect_b32 s27, s18, s22
    s_cselect_b32 s28, s20, s22
    s_add_u32 m0, s26, 0
    s_nop 0
    buffer_load_dwordx4 v0, s[8:11], s27 offen lds
    s_add_u32 s27, s27, 20480
    s_add_u32 m0, s26, 4096
    s_nop 0
    buffer_load_dwordx4 v0, s[8:11], s27 offen lds
    s_add_u32 s27, s27, 20480
    s_add_u32 m0, s26, 8192
    s_nop 0
    buffer_load_dwordx4 v0, s[8:11], s27 offen lds
    s_add_u32 s27, s27, 20480
    s_add_u32 m0, s26, 12288
    s_nop 0
    buffer_load_dwordx4 v0, s[8:11], s27 offen lds
    s_add_u32 m0, s26, 16384
    s_nop 0
    buffer_load_dwordx4 v2, s[4:7], s28 offen lds
    s_add_u32 s28, s28, 4096
    s_add_u32 m0, s26, 20480
    s_nop 0
    buffer_load_dwordx4 v2, s[4:7], s28 offen lds
    s_add_u32 s28, s28, 4096
    s_add_u32 m0, s26, 24576
    s_nop 0
    buffer_load_dwordx4 v2, s[4:7], s28 offen lds
    s_add_u32 s18, s18, 81920
    s_add_u32 s20, s20, 294912
    s_mov_b32 s23, 0
    s_add_u32 s24, s17, 114688
    s_mov_b32 s25, 0
    s_waitcnt vmcnt(21)
    s_barrier
    v_add_u32 v120, 0, v1
    v_add_u32 v124, 0, v3
    v_xor_b32 v121, 32, v120
    v_xor_b32 v122, 64, v120
    v_xor_b32 v123, 96, v120
    v_xor_b32 v125, 64, v124
    ds_read_b128 v[96:99], v124
    ds_read_b128 v[100:103], v124 offset:2048
    ds_read_b128 v[104:107], v124 offset:4096
    ds_read_b64_tr_b16 v[16:17], v120
    ds_read_b64_tr_b16 v[18:19], v120 offset:1024
    ds_read_b64_tr_b16 v[20:21], v121
    ds_read_b64_tr_b16 v[22:23], v121 offset:1024
    ds_read_b64_tr_b16 v[24:25], v122
    ds_read_b64_tr_b16 v[26:27], v122 offset:1024
    s_nop 3
oproj_kernel_loop:
    s_waitcnt vmcnt(14)
    s_barrier
    s_cmp_lt_u32 s18, s19
    s_cselect_b32 s27, s18, s22
    s_cselect_b32 s28, s20, s22
    s_add_u32 s18, s18, 81920
    s_add_u32 s20, s20, 294912
    v_mov_b32 v8, v120
    v_mov_b32 v9, v121
    v_mov_b32 v10, v122
    v_mov_b32 v11, v123
    v_mov_b32 v12, v124
    v_mov_b32 v13, v125
    s_add_u32 s29, s23, 28672
    s_cmp_eq_u32 s29, 143360
    s_cselect_b32 s29, 0, s29
    v_add_u32 v120, s29, v1
    v_add_u32 v124, s29, v3
    v_xor_b32 v121, 32, v120
    v_xor_b32 v122, 64, v120
    v_xor_b32 v123, 96, v120
    v_xor_b32 v125, 64, v124
    s_waitcnt lgkmcnt(4)
    v_mfma_f32_16x16x32_bf16 v[48:51], v[16:19], v[96:99], v[48:51]
    v_mfma_f32_16x16x32_bf16 v[52:55], v[16:19], v[100:103], v[52:55]
    v_mfma_f32_16x16x32_bf16 v[56:59], v[16:19], v[104:107], v[56:59]
    ds_read_b128 v[108:111], v13
    ds_read_b128 v[112:115], v13 offset:2048
    ds_read_b128 v[116:119], v13 offset:4096
    ds_read_b64_tr_b16 v[28:29], v11
    ds_read_b64_tr_b16 v[30:31], v11 offset:1024
    s_add_u32 m0, s24, 0
    s_nop 0
    buffer_load_dwordx4 v0, s[8:11], s27 offen lds
    s_add_u32 s27, s27, 20480
    s_waitcnt lgkmcnt(7)
    v_mfma_f32_16x16x32_bf16 v[60:63], v[20:23], v[96:99], v[60:63]
    v_mfma_f32_16x16x32_bf16 v[64:67], v[20:23], v[100:103], v[64:67]
    v_mfma_f32_16x16x32_bf16 v[68:71], v[20:23], v[104:107], v[68:71]
    ds_read_b64_tr_b16 v[32:33], v8 offset:8192
    ds_read_b64_tr_b16 v[34:35], v8 offset:9216
    s_add_u32 m0, s24, 4096
    s_nop 0
    buffer_load_dwordx4 v0, s[8:11], s27 offen lds
    s_add_u32 s27, s27, 20480
    s_waitcnt lgkmcnt(7)
    v_mfma_f32_16x16x32_bf16 v[72:75], v[24:27], v[96:99], v[72:75]
    v_mfma_f32_16x16x32_bf16 v[76:79], v[24:27], v[100:103], v[76:79]
    v_mfma_f32_16x16x32_bf16 v[80:83], v[24:27], v[104:107], v[80:83]
    ds_read_b64_tr_b16 v[36:37], v9 offset:8192
    ds_read_b64_tr_b16 v[38:39], v9 offset:9216
    s_add_u32 m0, s24, 8192
    s_nop 0
    buffer_load_dwordx4 v0, s[8:11], s27 offen lds
    s_add_u32 s27, s27, 20480
    s_waitcnt lgkmcnt(4)
    v_mfma_f32_16x16x32_bf16 v[84:87], v[28:31], v[96:99], v[84:87]
    v_mfma_f32_16x16x32_bf16 v[88:91], v[28:31], v[100:103], v[88:91]
    v_mfma_f32_16x16x32_bf16 v[92:95], v[28:31], v[104:107], v[92:95]
    ds_read_b64_tr_b16 v[40:41], v10 offset:8192
    ds_read_b64_tr_b16 v[42:43], v10 offset:9216
    s_add_u32 m0, s24, 12288
    s_nop 0
    buffer_load_dwordx4 v0, s[8:11], s27 offen lds
    s_add_u32 s27, s27, 20480
    s_waitcnt lgkmcnt(4)
    v_mfma_f32_16x16x32_bf16 v[48:51], v[32:35], v[108:111], v[48:51]
    v_mfma_f32_16x16x32_bf16 v[52:55], v[32:35], v[112:115], v[52:55]
    v_mfma_f32_16x16x32_bf16 v[56:59], v[32:35], v[116:119], v[56:59]
    ds_read_b128 v[96:99], v124
    ds_read_b128 v[100:103], v124 offset:2048
    ds_read_b128 v[104:107], v124 offset:4096
    ds_read_b64_tr_b16 v[44:45], v11 offset:8192
    ds_read_b64_tr_b16 v[46:47], v11 offset:9216
    s_add_u32 m0, s24, 16384
    s_nop 0
    buffer_load_dwordx4 v2, s[4:7], s28 offen lds
    s_add_u32 s28, s28, 4096
    s_waitcnt lgkmcnt(7)
    v_mfma_f32_16x16x32_bf16 v[60:63], v[36:39], v[108:111], v[60:63]
    v_mfma_f32_16x16x32_bf16 v[64:67], v[36:39], v[112:115], v[64:67]
    v_mfma_f32_16x16x32_bf16 v[68:71], v[36:39], v[116:119], v[68:71]
    ds_read_b64_tr_b16 v[16:17], v120
    ds_read_b64_tr_b16 v[18:19], v120 offset:1024
    s_add_u32 m0, s24, 20480
    s_nop 0
    buffer_load_dwordx4 v2, s[4:7], s28 offen lds
    s_add_u32 s28, s28, 4096
    s_waitcnt lgkmcnt(7)
    v_mfma_f32_16x16x32_bf16 v[72:75], v[40:43], v[108:111], v[72:75]
    v_mfma_f32_16x16x32_bf16 v[76:79], v[40:43], v[112:115], v[76:79]
    v_mfma_f32_16x16x32_bf16 v[80:83], v[40:43], v[116:119], v[80:83]
    ds_read_b64_tr_b16 v[20:21], v121
    ds_read_b64_tr_b16 v[22:23], v121 offset:1024
    s_add_u32 m0, s24, 24576
    s_nop 0
    buffer_load_dwordx4 v2, s[4:7], s28 offen lds
    s_add_u32 s28, s28, 4096
    s_waitcnt lgkmcnt(4)
    v_mfma_f32_16x16x32_bf16 v[84:87], v[44:47], v[108:111], v[84:87]
    v_mfma_f32_16x16x32_bf16 v[88:91], v[44:47], v[112:115], v[88:91]
    v_mfma_f32_16x16x32_bf16 v[92:95], v[44:47], v[116:119], v[92:95]
    ds_read_b64_tr_b16 v[24:25], v122
    ds_read_b64_tr_b16 v[26:27], v122 offset:1024
    s_add_u32 s24, s23, s17
    s_mov_b32 s23, s29
    s_add_u32 s25, s25, 1
    s_cmp_lt_u32 s25, 96
    s_cbranch_scc1 oproj_kernel_loop
    s_waitcnt lgkmcnt(0)
    v_mbcnt_lo_u32_b32 v7, -1, 0
    v_mbcnt_hi_u32_b32 v7, -1, v7
    v_and_b32 v8, 15, v7
    v_lshrrev_b32 v9, 4, v7
    v_add_u32 v8, s42, v8
    v_mul_u32_u24 v8, 2560, v8
    v_lshl_add_u32 v8, v9, 4, v8
    s_mul_i32 s26, s30, 1280
    s_lshl_b32 s27, s32, 8
    s_add_u32 s26, s26, s27
    s_and_b32 s27, s16, 1
    s_lshl_b32 s27, s27, 7
    s_add_u32 s26, s26, s27
    v_cvt_pk_bf16_f32 v16, v48, v49
    v_cvt_pk_bf16_f32 v17, v50, v51
    v_cvt_pk_bf16_f32 v18, v60, v61
    v_cvt_pk_bf16_f32 v19, v62, v63
    s_nop 0
    v_permlane32_swap_b32 v16, v18
    v_permlane32_swap_b32 v17, v19
    s_nop 0
    v_permlane16_swap_b32 v16, v18
    v_permlane16_swap_b32 v17, v19
    buffer_store_dwordx4 v[16:19], v8, s[12:15], s26 offen
    v_cvt_pk_bf16_f32 v20, v72, v73
    v_cvt_pk_bf16_f32 v21, v74, v75
    v_cvt_pk_bf16_f32 v22, v84, v85
    v_cvt_pk_bf16_f32 v23, v86, v87
    s_nop 0
    v_permlane32_swap_b32 v20, v22
    v_permlane32_swap_b32 v21, v23
    s_nop 0
    v_permlane16_swap_b32 v20, v22
    v_permlane16_swap_b32 v21, v23
    buffer_store_dwordx4 v[20:23], v8, s[12:15], s26 offen offset:64
    s_nop 0
    s_add_u32 s26, s26, 40960
    v_cvt_pk_bf16_f32 v24, v52, v53
    v_cvt_pk_bf16_f32 v25, v54, v55
    v_cvt_pk_bf16_f32 v26, v64, v65
    v_cvt_pk_bf16_f32 v27, v66, v67
    s_nop 0
    v_permlane32_swap_b32 v24, v26
    v_permlane32_swap_b32 v25, v27
    s_nop 0
    v_permlane16_swap_b32 v24, v26
    v_permlane16_swap_b32 v25, v27
    buffer_store_dwordx4 v[24:27], v8, s[12:15], s26 offen
    v_cvt_pk_bf16_f32 v28, v76, v77
    v_cvt_pk_bf16_f32 v29, v78, v79
    v_cvt_pk_bf16_f32 v30, v88, v89
    v_cvt_pk_bf16_f32 v31, v90, v91
    s_nop 0
    v_permlane32_swap_b32 v28, v30
    v_permlane32_swap_b32 v29, v31
    s_nop 0
    v_permlane16_swap_b32 v28, v30
    v_permlane16_swap_b32 v29, v31
    buffer_store_dwordx4 v[28:31], v8, s[12:15], s26 offen offset:64
    s_nop 0
    s_add_u32 s26, s26, 40960
    v_cvt_pk_bf16_f32 v32, v56, v57
    v_cvt_pk_bf16_f32 v33, v58, v59
    v_cvt_pk_bf16_f32 v34, v68, v69
    v_cvt_pk_bf16_f32 v35, v70, v71
    s_nop 0
    v_permlane32_swap_b32 v32, v34
    v_permlane32_swap_b32 v33, v35
    s_nop 0
    v_permlane16_swap_b32 v32, v34
    v_permlane16_swap_b32 v33, v35
    buffer_store_dwordx4 v[32:35], v8, s[12:15], s26 offen
    v_cvt_pk_bf16_f32 v36, v80, v81
    v_cvt_pk_bf16_f32 v37, v82, v83
    v_cvt_pk_bf16_f32 v38, v92, v93
    v_cvt_pk_bf16_f32 v39, v94, v95
    s_nop 0
    v_permlane32_swap_b32 v36, v38
    v_permlane32_swap_b32 v37, v39
    s_nop 0
    v_permlane16_swap_b32 v36, v38
    v_permlane16_swap_b32 v37, v39
    buffer_store_dwordx4 v[36:39], v8, s[12:15], s26 offen offset:64
oproj_kernel_exit:
    s_endpgm
.section .rodata,"a"
.p2align 6
.amdhsa_kernel attn_kernel
  .amdhsa_next_free_vgpr 256
  .amdhsa_next_free_sgpr 102
  .amdhsa_accum_offset 256
  .amdhsa_group_segment_fixed_size 0
  .amdhsa_kernarg_size 104
  .amdhsa_user_sgpr_count 2
  .amdhsa_user_sgpr_kernarg_segment_ptr 1
  .amdhsa_system_sgpr_workgroup_id_x 1
.end_amdhsa_kernel
.p2align 6
.amdhsa_kernel oproj_kernel
  .amdhsa_next_free_vgpr 128
  .amdhsa_next_free_sgpr 96
  .amdhsa_accum_offset 128
  .amdhsa_group_segment_fixed_size 0
  .amdhsa_kernarg_size 104
  .amdhsa_user_sgpr_count 2
  .amdhsa_user_sgpr_kernarg_segment_ptr 1
  .amdhsa_system_sgpr_workgroup_id_x 1
.end_amdhsa_kernel
```
